```python
import torch

def _softmax(x, axis=-1):
    return torch.softmax(x, dim=axis)
def _gelu(x):
    return torch.nn.functional.gelu(x, approximate="tanh")
def _silu(x):
    return torch.nn.functional.silu(x)
def _sigmoid(x):
    return torch.sigmoid(x)
def _layernorm(x, axis=-1, eps=1e-5):
    m = x.mean(dim=axis, keepdim=True)
    v = x.var(dim=axis, keepdim=True, unbiased=False)
    return (x - m) / torch.sqrt(v + eps)
def _scatter_add(tgt, idx, src, axis=0):
    return tgt.clone().index_add_(axis, idx, src)
def _segment_sum(src, seg, n):
    out = torch.zeros((n,) + src.shape[1:], dtype=src.dtype)
    return out.index_add_(0, seg, src)
def _pad(x, pw):
    flat = tuple(v for pair in reversed(pw) for v in pair)
    return torch.nn.functional.pad(x, flat)

kernel_name = 'sequential_preLN__linear_kernel_hedgehog__mixer_token_mlp__prompt'

def setup_inputs():

    _w = (lambda a: (lambda t: t.to(torch.bfloat16) if t.is_floating_point() else t)(torch.as_tensor(a)))
    def _A_setup():
        B, S, D, H = 1, 2048, 512, 32
        Dh = D // H
        return {
            "x": _w((lambda *s: torch.randn(*s, dtype=torch.bfloat16) * 0.05)(B, S, D)),
            "wqkv": _w((lambda *s: torch.randn(*s, dtype=torch.bfloat16) * 0.2)(D, 3 * D)),
            "w_phi": _w((lambda *s: torch.randn(*s, dtype=torch.bfloat16) * 0.2)(H, Dh, Dh) * (Dh ** -0.5)),
            "wo": _w((lambda *s: torch.randn(*s, dtype=torch.bfloat16) * 0.05)(D, D)),
        }
    _A_in = _A_setup()

    def _B_setup():
        B, S, D, F = 1, 2048, 512, 1792
        return {
            "x": _w((lambda *s: torch.randn(*s, dtype=torch.bfloat16) * 0.05)(B, S, D)),
            "w1": _w((lambda *s: torch.randn(*s, dtype=torch.bfloat16) * 0.4)(S, F) * (S ** -0.5)),
            "b1": _w((lambda *s: torch.randn(*s, dtype=torch.bfloat16) * 12.8)(F) * 0.02),
            "w2": _w((lambda *s: torch.randn(*s, dtype=torch.bfloat16) * 0.2)(F, S) * (F ** -0.5)),
            "b2": _w((lambda *s: torch.randn(*s, dtype=torch.bfloat16) * 3.2)(S) * 0.02),
        }
    _B_in = _B_setup()

    return {
        "A_x": _A_in["x"],
        "A_wqkv": _A_in["wqkv"],
        "A_w_phi": _A_in["w_phi"],
        "A_wo": _A_in["wo"],
        "B_x": _B_in["x"],
        "B_w1": _B_in["w1"],
        "B_b1": _B_in["b1"],
        "B_w2": _B_in["w2"],
        "B_b2": _B_in["b2"],
    }

def reference(A_x, A_wqkv, A_w_phi, A_wo, B_x, B_w1, B_b1, B_w2, B_b2):
    def _A_ref(x, wqkv, w_phi, wo):
        B, S, D = x.shape
        H = 32; Dh = D // H
        qkv = (lambda x, *d: x.permute(*d))((x @ wqkv).reshape(B, S, 3, H, Dh), 2, 0, 3, 1, 4)
        q, k, v = qkv[0], qkv[1], qkv[2]
        pq = torch.einsum("bhsd,hdf->bhsf", q, w_phi)
        pk = torch.einsum("bhsd,hdf->bhsf", k, w_phi)
        phi_q = torch.concatenate([_softmax(pq, axis=-1), _softmax(-pq, axis=-1)], axis=-1)
        phi_k = torch.concatenate([_softmax(pk, axis=-1), _softmax(-pk, axis=-1)], axis=-1)
        kv = torch.einsum("bhsf,bhsd->bhfd", phi_k, v)
        z  = torch.einsum("bhsf->bhf", phi_k)
        num = torch.einsum("bhqf,bhfd->bhqd", phi_q, kv)
        den = torch.einsum("bhqf,bhf->bhq", phi_q, z)[..., None] + 1e-6
        o = num / den
        return (lambda x, *d: x.permute(*d))(o, 0, 2, 1, 3).reshape(B, S, D) @ wo

    def _B_ref(x, w1, b1, w2, b2):
        B, S, D = x.shape
        h = _layernorm(x, axis=-1)
        u = torch.einsum("bsd,sf->bdf", h, w1) + b1
        u = _gelu(u)
        y = torch.einsum("bdf,fs->bds", u, w2) + b2
        return (lambda x, *d: x.permute(*d))(y, 0, 2, 1)

    x = A_x
    h = x + _A_ref(_layernorm(x, axis=-1), A_wqkv, A_w_phi, A_wo)
    h2 = h + _B_ref(_layernorm(h, axis=-1), B_w1, B_b1, B_w2, B_b2)
    return h2
```

```asm
; @launch grid=(256,1,1) block=(256,1,1) lds=163840
.amdgcn_target "amdgcn-amd-amdhsa--gfx950"
.text
.globl sequential_preLN__linear_kernel_hedgehog__mixer_token_mlp__prompt_kernel
.p2align 8
.type sequential_preLN__linear_kernel_hedgehog__mixer_token_mlp__prompt_kernel,@function
sequential_preLN__linear_kernel_hedgehog__mixer_token_mlp__prompt_kernel:
    v_readfirstlane_b32 s48, v0
    s_cmp_ge_u32 s2, 256
    s_cbranch_scc1 L_end
    s_lshr_b32 s48, s48, 6
    s_load_dwordx2 s[8:9], s[0:1], 0
    s_load_dwordx2 s[12:13], s[0:1], 8
    v_and_b32 v0, 63, v0
    s_lshr_b32 s5, s2, 3
    s_getpc_b64 s[6:7]
    s_lshl_b32 s4, s5, 2
    s_add_u32 s4, s4, s48
    s_lshl_b32 s4, s4, 9
    v_and_b32 v14, 3, v0
    v_lshl_add_u32 v14, v14, 7, s4
    v_min_u32 v14, 25412, v14
    s_mov_b64 exec, 15
    global_load_dword v63, v14, s[6:7]
    s_mov_b64 exec, -1
    s_and_b32 s4, s2, 7
    s_lshr_b32 s49, s5, 3
    s_lshl2_add_u32 s49, s4, s49
    s_and_b32 s50, s5, 7
    v_lshrrev_b32 v14, 3, v0
    v_and_b32 v15, 7, v0
    s_lshl_b32 s61, s48, 4
    v_add_u32 v17, s61, v14
    v_lshrrev_b32 v16, 1, v14
    v_xor_b32 v18, v15, v16
    v_lshlrev_b32 v18, 4, v18
    v_lshl_add_u32 v252, v17, 10, v18
    v_and_b32 v16, 1, v16
    v_lshlrev_b32 v16, 2, v16
    v_xor_b32 v16, v15, v16
    v_mul_u32_u24 v17, 3072, v17
    v_lshl_add_u32 v254, v16, 4, v17
    v_xor_b32 v253, 64, v252
    v_add_u32 v253, 7168, v253
    v_add_u32 v255, 23552, v254
    s_lshl_b32 s68, s49, 16
    s_lshl_b32 s69, s50, 7
    s_lshl_b32 s66, s48, 11
    s_add_u32 s70, s49, s50
    s_and_b32 s70, s70, 3
    s_lshl_b32 s70, s70, 1
    s_mov_b32 s10, 2097152
    s_mov_b32 s11, 0x20000
    s_mov_b32 s14, 1572864
    s_mov_b32 s15, 0x20000
    s_waitcnt lgkmcnt(0)
    s_lshr_b32 s5, s2, 3
    s_sub_u32 s4, s5, s48
    s_mul_i32 s4, s4, 49152
    v_add_u32 v20, s4, v254
    s_add_u32 s4, s48, 1
    s_lshl_b32 s4, s4, 10
    s_cmp_eq_u32 s4, 3072
    s_cselect_b32 s4, 0, s4
    s_add_u32 s4, s4, 384
    s_cmp_eq_u32 s48, 3
    s_cselect_b32 s4, 1879048192, s4
    s_lshl_b32 s6, s48, 14
    s_add_u32 m0, s6, 112640
    s_add_u32 s6, s4, 24576
    buffer_load_dwordx4 v20, s[12:15], s4 offen lds
    buffer_load_dwordx4 v20, s[12:15], s6 offen lds
    s_load_dwordx2 s[72:73], s[0:1], 16
    s_load_dwordx2 s[16:17], s[0:1], 88
    s_load_dwordx2 s[20:21], s[0:1], 24
    s_load_dwordx2 s[24:25], s[0:1], 40
    s_load_dwordx2 s[40:41], s[0:1], 48
    s_load_dwordx2 s[28:29], s[0:1], 56
    s_and_b32 s4, s2, 7
    s_lshl_b32 s4, s4, 5
    s_add_u32 s4, s4, s5
    s_sub_u32 s4, s4, 6
    s_lshl_b32 s4, s4, 13
    v_add_u32 v20, s4, v252
    s_movk_i32 s4, 384
    s_cmp_eq_u32 s48, 3
    s_cselect_b32 s4, s4, 1879048192
    buffer_load_dwordx4 v20, s[8:11], s4 offen lds
    s_load_dwordx2 s[44:45], s[0:1], 64
    s_load_dwordx2 s[32:33], s[0:1], 72
    s_mov_b32 s74, 16384
    s_mov_b32 s75, 0x20000
    s_mov_b32 s18, 16777216
    s_mov_b32 s19, 0x20000
    s_add_u32 s71, s70, 0
    s_and_b32 s71, s71, 7
    s_lshl_b32 s60, s71, 7
    s_add_u32 m0, s66, 73728
    s_add_u32 s60, s60, s68
    buffer_load_dwordx4 v252, s[8:11], s60 offen lds
    s_mov_b32 s22, 524288
    s_mov_b32 s23, 0x20000
    s_mov_b32 s26, 7340032
    s_mov_b32 s27, 0x20000
    s_mov_b32 s42, 3584
    s_mov_b32 s43, 0x20000
    buffer_load_dwordx4 v253, s[8:11], s60 offen offset:1024 lds
    s_mov_b32 s30, 7340032
    s_mov_b32 s31, 0x20000
    s_mov_b32 s46, 4096
    s_mov_b32 s47, 0x20000
    s_mov_b32 s34, 2097152
    s_mov_b32 s35, 0x20000
    s_mul_i32 s71, s71, 196608
    s_add_u32 s71, s71, s69
    s_add_u32 m0, s66, 0
    s_add_u32 s60, s71, 1024
    buffer_load_dwordx4 v254, s[12:15], s60 offen lds
    s_lshr_b32 s58, s48, 1
    s_and_b32 s59, s48, 1
    v_and_b32 v1, 31, v0
    v_lshrrev_b32 v2, 5, v0
    v_lshlrev_b32 v3, 4, v0
    s_lshl_b32 s65, s50, 11
    buffer_load_dwordx4 v255, s[12:15], s60 offen offset:1024 lds
    s_lshl_b32 s62, s59, 10
    s_add_u32 s65, s65, s62
    s_lshl_b32 s64, s48, 14
    s_nop 0
    s_add_u32 s64, s64, 110592
    v_bfe_u32 v15, v0, 2, 2
    v_lshl_add_u32 v21, v2, 2, v15
    s_add_u32 m0, s66, 24576
    s_add_u32 s60, s71, 2048
    buffer_load_dwordx4 v254, s[12:15], s60 offen lds
    v_lshl_add_u32 v56, v21, 5, s64
    v_bfe_u32 v15, v0, 4, 1
    v_lshl_add_u32 v56, v15, 9, v56
    v_and_b32 v15, 3, v0
    v_lshl_add_u32 v56, v15, 3, v56
    s_mov_b32 s67, 0x3f803f80
    buffer_load_dwordx4 v255, s[12:15], s60 offen offset:1024 lds
    s_lshl1_add_u32 s61, s59, s58
    v_bfe_u32 v14, v1, 1, 3
    v_xor_b32 v14, v14, v2
    s_lshl_b32 s62, s61, 1
    v_xor_b32 v14, s62, v14
    v_lshlrev_b32 v14, 4, v14
    s_add_u32 s71, s70, 1
    s_and_b32 s71, s71, 7
    s_lshl_b32 s60, s71, 7
    s_add_u32 m0, s66, 81920
    s_add_u32 s60, s60, s68
    buffer_load_dwordx4 v252, s[8:11], s60 offen lds
    v_lshl_add_u32 v14, v1, 7, v14
    s_lshl_b32 s62, s58, 12
    s_add_u32 s62, s62, 73728
    v_add_u32 v240, s62, v14
    v_xor_b32 v241, 32, v240
    v_xor_b32 v242, 64, v240
    buffer_load_dwordx4 v253, s[8:11], s60 offen offset:1024 lds
    v_xor_b32 v243, 96, v240
    v_bfe_u32 v15, v0, 2, 2
    v_lshl_add_u32 v200, v2, 3, v15
    v_lshlrev_b32 v200, 7, v200
    v_lshrrev_b32 v15, 1, v15
    v_lshl_add_u32 v200, v15, 6, v200
    s_mul_i32 s71, s71, 196608
    s_add_u32 s71, s71, s69
    s_add_u32 m0, s66, 8192
    s_add_u32 s60, s71, 1024
    buffer_load_dwordx4 v254, s[12:15], s60 offen lds
    v_bfe_u32 v15, v0, 4, 1
    v_lshl_add_u32 v200, v15, 5, v200
    v_and_b32 v15, 3, v0
    v_lshl_add_u32 v200, v15, 3, v200
    s_lshl_b32 s62, s59, 6
    v_xor_b32 v14, s62, v200
    buffer_load_dwordx4 v255, s[12:15], s60 offen offset:1024 lds
    s_lshl_b32 s62, s61, 11
    v_add_u32 v244, s62, v14
    v_xor_b32 v245, 2048, v244
    v_xor_b32 v246, 4096, v244
    v_xor_b32 v247, 6144, v244
    v_add_u32 v248, 24576, v244
    s_add_u32 m0, s66, 32768
    s_add_u32 s60, s71, 2048
    buffer_load_dwordx4 v254, s[12:15], s60 offen lds
    v_add_u32 v249, 24576, v245
    v_add_u32 v250, 24576, v246
    v_add_u32 v251, 24576, v247
    v_mov_b32 v8, 0
    v_mov_b32 v9, 0
    v_mov_b32 v10, 0
    buffer_load_dwordx4 v255, s[12:15], s60 offen offset:1024 lds
    v_mov_b32 v11, 0
    s_waitcnt lgkmcnt(0)
    s_mov_b32 m0, s64
    s_nop 0
    buffer_load_dwordx4 v3, s[72:75], s65 offen lds
    v_mov_b32 v13, 0
    buffer_load_dword v13, v13, s[16:19], 0 offen sc1
    s_lshr_b32 s63, s49, 1
    s_lshl4_add_u32 s61, s50, s63
    s_and_b32 s63, s49, 1
    s_add_u32 s62, s63, s48
    s_cmp_eq_u32 s62, 1
    s_cselect_b32 s51, 2, 0
    s_cmp_eq_u32 s48, 0
    s_cselect_b32 s51, 1, s51
    s_cselect_b32 s63, s63, 2
    s_lshl2_add_u32 s73, s61, s63
    s_sub_u32 s52, s73, s61
    s_lshl_b32 s73, s73, 7
    s_add_u32 s73, s73, 65536
    s_lshl_b32 s52, s52, 13
    s_add_u32 s52, s52, 1048576
    s_add_u32 s79, s52, 4096
    v_mov_b32 v52, -1
    v_mov_b32 v53, -1
    v_mov_b32 v54, -1
    v_mov_b32 v55, -1
    s_and_b32 s61, s2, 7
    s_lshr_b32 s63, s2, 3
    s_and_b32 s62, s61, 1
    s_and_b32 s54, s63, 3
    s_lshl2_add_u32 s54, s62, s54
    s_lshr_b32 s61, s61, 1
    s_lshr_b32 s63, s63, 2
    s_lshl3_add_u32 s56, s61, s63
    s_sub_u32 s55, s56, s61
    s_mul_i32 s1, s48, 1835008
    s_lshl_b32 s62, s55, 7
    s_add_u32 s1, s1, s62
    s_cmp_lt_u32 s63, 7
    s_cselect_b32 s57, 1, 0
    s_cselect_b32 s1, s1, 1879048192
    s_and_b32 s61, s49, 1
    s_xor_b32 s61, s61, s50
    s_lshl3_add_u32 s61, s49, s61
    s_lshl2_add_u32 s4, s61, s48
    s_lshl_b32 s4, s4, 11
    s_add_u32 s4, s4, 6291456
    s_lshl1_add_u32 s61, s61, s59
    s_lshl2_add_u32 s61, s61, s58
    s_lshl_b32 s61, s61, 10
    s_add_u32 s72, s61, 4194304
    s_lshl1_add_u32 s63, s49, s59
    s_lshl3_add_u32 s61, s63, s50
    s_lshl1_add_u32 s61, s61, s58
    s_lshl_b32 s61, s61, 8
    s_add_u32 s74, s61, 262144
    s_and_b32 s61, s72, 0xffffe000
    s_lshl2_add_u32 s63, s59, s58
    s_lshl_b32 s63, s63, 10
    s_add_u32 s75, s61, s63
    s_mul_i32 s61, s54, 28
    s_add_u32 s61, s61, s55
    s_lshl1_add_u32 s61, s61, s58
    s_lshl2_add_u32 s61, s61, s59
    s_lshl_b32 s61, s61, 10
    s_add_u32 s76, s61, 1048576
    s_lshl_b32 s0, s48, 17
    s_lshl_b32 s62, s50, 7
    s_add_u32 s0, s0, s62
    s_lshl_b32 s77, s48, 14
    s_add_u32 s77, s77, 98304
    v_bfe_u32 v15, v0, 2, 2
    v_lshl_add_u32 v198, v2, 2, v15
    v_lshlrev_b32 v198, 7, v198
    v_lshrrev_b32 v15, 1, v15
    v_lshl_add_u32 v198, v15, 6, v198
    v_bfe_u32 v15, v0, 4, 1
    v_lshl_add_u32 v198, v15, 5, v198
    v_and_b32 v15, 3, v0
    v_lshl_add_u32 v198, v15, 3, v198
    s_lshl_b32 s61, s58, 6
    v_xor_b32 v198, s61, v198
    v_xor_b32 v200, s61, v200
    s_lshl_b32 s78, s48, 13
    s_add_u32 s78, s78, 61440
    v_add_u32 v202, s78, v198
    v_add_u32 v198, s77, v198
    v_add_u32 v200, s77, v200
    v_xor_b32 v199, 64, v198
    v_xor_b32 v201, 64, v200
    v_xor_b32 v203, 64, v202
    v_lshrrev_b32 v14, 3, v0
    v_mul_u32_u24 v192, 1024, v14
    v_bfe_u32 v14, v0, 4, 1
    v_lshlrev_b32 v14, 2, v14
    v_and_b32 v15, 7, v0
    v_xor_b32 v14, v14, v15
    v_lshl_add_u32 v192, v14, 4, v192
    v_lshrrev_b32 v14, 3, v0
    s_movk_i32 s61, 2560
    v_mad_u32_u24 v194, v14, s61, v192
    s_movk_i32 s61, 3072
    v_mad_u32_u24 v196, v14, s61, v192
    v_add_u32 v193, 7168, v192
    v_add_u32 v195, 27648, v194
    v_add_u32 v197, 31744, v196
    s_lshr_b32 s63, s2, 3
    s_lshr_b32 s61, s63, 4
    s_and_b32 s63, s63, 15
    s_bfe_u32 s99, s2, 0x20001
    s_mul_i32 s98, s61, 1835008
    s_mul_i32 s62, s63, 3584
    s_add_u32 s98, s98, s62
    s_mul_i32 s62, s99, 896
    s_add_u32 s98, s98, s62
    v_add_u32 v226, s98, v3
    v_mov_b32 v15, 1879048192
    v_cmp_gt_u32 vcc, 56, v0
    s_nop 1
    v_cndmask_b32 v226, v15, v226, vcc
    s_mul_i32 s98, s61, 1835008
    s_lshl_b32 s62, s63, 12
    s_add_u32 s98, s98, s62
    s_lshl_b32 s62, s99, 10
    s_add_u32 s98, s98, s62
    v_add_u32 v227, s98, v3
    s_lshr_b32 s61, s2, 6
    s_bfe_u32 s63, s2, 0x30003
    s_and_b32 s99, s2, 7
    s_mul_i32 s98, s61, 1835008
    s_lshl_b32 s62, s63, 13
    s_add_u32 s98, s98, s62
    s_lshl_b32 s62, s99, 9
    s_add_u32 s98, s98, s62
    v_lshl_add_u32 v227, v1, 4, s98
    v_lshl_add_u32 v227, v2, 12, v227
    s_and_b32 s61, s2, 1
    s_mul_i32 s98, s48, 57344
    s_mul_i32 s62, s61, 3670016
    s_add_u32 s98, s98, s62
    s_lshl_b32 s99, s48, 16
    v_bfe_u32 v14, v1, 1, 2
    v_lshlrev_b32 v218, 1, v2
    v_xor_b32 v14, v14, v218
    v_lshlrev_b32 v14, 4, v14
    v_lshl_add_u32 v218, v1, 6, v14
    s_mul_i32 s61, s59, 24576
    s_lshl_b32 s62, s58, 11
    s_add_u32 s61, s61, s62
    s_add_u32 s61, s61, 8192
    v_add_u32 v233, s61, v218
    v_xor_b32 v234, 16, v233
    v_bfe_u32 v14, v0, 2, 2
    v_lshl_add_u32 v220, v2, 3, v14
    v_lshlrev_b32 v220, 6, v220
    v_lshrrev_b32 v14, 1, v14
    v_bfe_u32 v15, v0, 4, 1
    v_xor_b32 v14, v14, v15
    v_and_b32 v15, 1, v0
    v_lshl_add_u32 v14, v15, 1, v14
    v_lshl_add_u32 v220, v14, 4, v220
    v_bfe_u32 v15, v0, 1, 1
    v_lshl_add_u32 v220, v15, 3, v220
    v_xor_b32 v221, 32, v220
    v_add_u32 v221, 256, v221
    s_mul_i32 s61, s58, 24576
    s_lshl_b32 s62, s59, 12
    s_add_u32 s61, s61, s62
    s_add_u32 s61, s61, 8192
    v_add_u32 v236, s61, v220
    v_add_u32 v237, s61, v221
    v_bfe_u32 v14, v1, 2, 1
    v_xor_b32 v14, v14, v2
    v_lshlrev_b32 v14, 4, v14
    v_lshl_add_u32 v14, v1, 5, v14
    s_lshl_b32 s61, s59, 12
    s_lshl_b32 s62, s58, 10
    s_add_u32 s61, s61, s62
    s_add_u32 s61, s61, 81920
    v_add_u32 v235, s61, v14
    v_bfe_u32 v14, v0, 2, 2
    v_lshl_add_u32 v14, v2, 3, v14
    v_lshlrev_b32 v14, 5, v14
    v_and_b32 v15, 1, v0
    v_lshl_add_u32 v14, v15, 4, v14
    v_bfe_u32 v15, v0, 1, 1
    v_lshl_add_u32 v14, v15, 3, v14
    s_lshl_b32 s61, s48, 11
    s_add_u32 s61, s61, 81920
    v_add_u32 v238, s61, v14
    v_xor_b32 v239, 16, v238
    v_add_u32 v239, 128, v239
    v_mov_b32 v14, 94208
    v_cmp_gt_u32 vcc, 16, v1
    s_nop 1
    v_cndmask_b32 v238, v14, v238, vcc
    v_cndmask_b32 v239, v14, v239, vcc
    s_lshl1_add_u32 s63, s59, s58
    s_lshl_b32 s61, s63, 8
    s_add_u32 s61, s61, 90112
    v_lshl_add_u32 v59, v0, 2, s61
    s_lshl_b32 s61, s48, 8
    s_add_u32 s61, s61, 91136
    v_lshl_add_u32 v60, v0, 2, s61
    s_lshl_b32 s61, s59, 9
    s_add_u32 s61, s61, 90112
    v_lshl_add_u32 v61, v2, 4, s61
    s_lshl_b32 s61, s58, 9
    s_add_u32 s61, s61, 91136
    v_lshl_add_u32 v62, v1, 2, s61
    v_mov_b32 v228, 0xffffff00
    v_and_b32 v15, 3, v0
    v_lshlrev_b32 v57, 9, v15
    v_add_u32 v57, 94208, v57
    s_lshl2_add_u32 s63, s50, s48
    s_mul_i32 s61, s63, 98304
    s_lshl_b32 s62, s49, 8
    s_add_u32 s61, s61, s62
    s_add_u32 s61, s61, 1048576
    v_mul_u32_u24 v231, 3, v2
    v_lshrrev_b32 v14, 3, v1
    v_add_u32 v231, v231, v14
    v_lshlrev_b32 v231, 13, v231
    v_and_b32 v14, 7, v1
    v_lshl_add_u32 v231, v14, 4, v231
    v_add_u32 v231, s61, v231
    s_mul_i32 s61, s49, 224
    v_subrev_u32 v14, s61, v231
    v_cmp_eq_u32 vcc, 16, v1
    s_nop 1
    v_cndmask_b32 v231, v231, v14, vcc
    v_mov_b32 v14, 128
    v_cndmask_b32 v14, v14, 16, vcc
    v_add_u32 v232, v14, v231
    s_lshl_b32 s61, s50, 13
    s_lshl_b32 s62, s59, 12
    s_add_u32 s61, s61, s62
    s_add_u32 s61, s61, 65536
    v_min_u32 v14, 16, v1
    v_lshlrev_b32 v14, 4, v14
    v_lshl_add_u32 v14, v2, 9, v14
    v_add_u32 v229, s61, v14
    s_mov_b32 s56, s49
    s_mul_i32 s3, s48, 1835008
    s_lshl_b32 s62, s56, 7
    s_add_u32 s3, s3, s62
    s_lshl_b32 s61, s59, 10
    v_add_u32 v204, s61, v3
    v_xor_b32 v205, 1024, v204
    s_lshl2_add_u32 s61, s49, s48
    s_lshl_b32 s61, s61, 8
    s_add_u32 s61, s61, 131072
    v_and_b32 v14, 1, v0
    v_lshl_add_u32 v206, v14, 7, s61
    s_lshl2_add_u32 s61, s54, s48
    s_lshl_b32 s61, s61, 10
    s_add_u32 s61, s61, 163840
    v_and_b32 v14, 7, v0
    v_lshl_add_u32 v207, v14, 7, s61
    s_lshl_b32 s61, s50, 12
    s_mul_i32 s62, s48, 896
    s_add_u32 s61, s61, s62
    s_add_u32 s61, s61, 196608
    v_and_b32 v14, 7, v0
    v_min_u32 v14, 6, v14
    v_lshl_add_u32 v208, v14, 7, s61
    s_lshl3_add_u32 s61, s49, s50
    s_lshl_b32 s96, s61, 7
    s_lshl_b32 s62, s48, 2
    s_add_u32 s96, s96, s62
    s_add_u32 s96, s96, 131072
    s_lshl_b32 s97, s50, 12
    s_lshl_b32 s62, s49, 7
    s_add_u32 s97, s97, s62
    s_lshl_b32 s62, s48, 2
    s_add_u32 s97, s97, s62
    s_add_u32 s97, s97, 163840
    s_lshl_b32 s94, s54, 12
    s_lshl_b32 s62, s55, 7
    s_add_u32 s94, s94, s62
    s_lshl_b32 s62, s48, 2
    s_add_u32 s94, s94, s62
    s_add_u32 s94, s94, 196608
    s_lshl_b32 s95, s49, 7
    s_lshl_b32 s62, s50, 2
    s_add_u32 s95, s95, s62
    s_add_u32 s95, s95, 4096
    v_and_b32 v14, 7, v0
    s_and_b32 s61, s95, 0xffffff80
    v_lshl_add_u32 v230, v14, 2, s61
    s_cmp_eq_u32 s48, 2
    s_cselect_b32 s95, s95, 16777216
    v_mov_b32 v225, 0
    s_xor_b32 s61, s48, 1
    s_mul_i32 s61, s61, 12288
    s_add_u32 s61, s61, 0
    v_add_u32 v209, s61, v3
    s_waitcnt vmcnt(8)
    s_barrier
    ds_read_b128 v[128:131], v240 offset:0
    ds_read_b64_tr_b16 v[64:65], v244 offset:0
    s_add_u32 s71, s70, 2
    s_and_b32 s71, s71, 7
    s_lshl_b32 s60, s71, 7
    s_add_u32 m0, s66, 90112
    s_add_u32 s60, s60, s68
    buffer_load_dwordx4 v252, s[8:11], s60 offen lds
    ds_read_b64_tr_b16 v[66:67], v244 offset:512
    ds_read_b64_tr_b16 v[80:81], v248 offset:0
    buffer_load_dwordx4 v253, s[8:11], s60 offen offset:1024 lds
    ds_read_b64_tr_b16 v[82:83], v248 offset:512
    ds_read_b128 v[132:135], v241 offset:0
    s_mul_i32 s71, s71, 196608
    s_add_u32 s71, s71, s69
    s_add_u32 m0, s66, 16384
    s_add_u32 s60, s71, 1024
    buffer_load_dwordx4 v254, s[12:15], s60 offen lds
    ds_read_b64_tr_b16 v[68:69], v245 offset:0
    ds_read_b64_tr_b16 v[70:71], v245 offset:512
    buffer_load_dwordx4 v255, s[12:15], s60 offen offset:1024 lds
    ds_read_b64_tr_b16 v[84:85], v249 offset:0
    ds_read_b64_tr_b16 v[86:87], v249 offset:512
    s_add_u32 m0, s66, 40960
    s_add_u32 s60, s71, 2048
    buffer_load_dwordx4 v254, s[12:15], s60 offen lds
    ds_read_b128 a[0:3], v242 offset:0
    ds_read_b64_tr_b16 v[72:73], v246 offset:0
    buffer_load_dwordx4 v255, s[12:15], s60 offen offset:1024 lds
    ds_read_b64_tr_b16 v[74:75], v246 offset:512
    ds_read_b64_tr_b16 v[88:89], v250 offset:0
    ds_read_b64_tr_b16 v[90:91], v250 offset:512
    ds_read_b128 a[4:7], v243 offset:0
    ds_read_b64_tr_b16 v[76:77], v247 offset:0
    ds_read_b64_tr_b16 v[78:79], v247 offset:512
    ds_read_b64_tr_b16 v[92:93], v251 offset:0
    ds_read_b64_tr_b16 v[94:95], v251 offset:512
    s_waitcnt vmcnt(8) lgkmcnt(0)
    s_barrier
    v_mfma_f32_32x32x16_bf16 v[16:31], v[64:67], v[128:131], 0
    ds_read_b128 v[136:139], v240 offset:8192
    ds_read_b64_tr_b16 v[96:97], v244 offset:8192
    s_add_u32 s71, s70, 3
    s_and_b32 s71, s71, 7
    s_lshl_b32 s60, s71, 7
    s_add_u32 m0, s66, 73728
    s_add_u32 s60, s60, s68
    buffer_load_dwordx4 v252, s[8:11], s60 offen lds
    v_mfma_f32_32x32x16_bf16 v[32:47], v[80:83], v[128:131], 0
    ds_read_b64_tr_b16 v[98:99], v244 offset:8704
    ds_read_b64_tr_b16 v[112:113], v248 offset:8192
    v_mfma_f32_32x32x16_bf16 v[16:31], v[68:71], v[132:135], v[16:31]
    ds_read_b64_tr_b16 v[114:115], v248 offset:8704
    ds_read_b128 v[140:143], v241 offset:8192
    buffer_load_dwordx4 v253, s[8:11], s60 offen offset:1024 lds
    v_mfma_f32_32x32x16_bf16 v[32:47], v[84:87], v[132:135], v[32:47]
    ds_read_b64_tr_b16 v[100:101], v245 offset:8192
    ds_read_b64_tr_b16 v[102:103], v245 offset:8704
    v_mfma_f32_32x32x16_bf16 v[16:31], v[72:75], a[0:3], v[16:31]
    ds_read_b64_tr_b16 v[116:117], v249 offset:8192
    ds_read_b64_tr_b16 v[118:119], v249 offset:8704
    s_mul_i32 s71, s71, 196608
    s_add_u32 s71, s71, s69
    s_add_u32 m0, s66, 0
    s_add_u32 s60, s71, 1024
    buffer_load_dwordx4 v254, s[12:15], s60 offen lds
    v_mfma_f32_32x32x16_bf16 v[32:47], v[88:91], a[0:3], v[32:47]
    ds_read_b128 a[8:11], v242 offset:8192
    ds_read_b64_tr_b16 v[104:105], v246 offset:8192
    v_mfma_f32_32x32x16_bf16 v[16:31], v[76:79], a[4:7], v[16:31]
    ds_read_b64_tr_b16 v[106:107], v246 offset:8704
    ds_read_b64_tr_b16 v[120:121], v250 offset:8192
    buffer_load_dwordx4 v255, s[12:15], s60 offen offset:1024 lds
    v_mfma_f32_32x32x16_bf16 v[32:47], v[92:95], a[4:7], v[32:47]
    ds_read_b64_tr_b16 v[122:123], v250 offset:8704
    ds_read_b128 a[12:15], v243 offset:8192
    ds_read_b64_tr_b16 v[108:109], v247 offset:8192
    s_add_u32 m0, s66, 24576
    s_add_u32 s60, s71, 2048
    buffer_load_dwordx4 v254, s[12:15], s60 offen lds
    v_dot2c_f32_bf16 v8, s67, v64
    v_dot2c_f32_bf16 v9, s67, v80
    ds_read_b64_tr_b16 v[110:111], v247 offset:8704
    v_dot2c_f32_bf16 v8, s67, v65
    v_dot2c_f32_bf16 v9, s67, v81
    ds_read_b64_tr_b16 v[124:125], v251 offset:8192
    v_dot2c_f32_bf16 v8, s67, v66
    v_dot2c_f32_bf16 v9, s67, v82
    ds_read_b64_tr_b16 v[126:127], v251 offset:8704
    v_dot2c_f32_bf16 v8, s67, v67
    v_dot2c_f32_bf16 v9, s67, v83
    v_dot2c_f32_bf16 v8, s67, v72
    v_dot2c_f32_bf16 v9, s67, v88
    v_dot2c_f32_bf16 v8, s67, v73
    v_dot2c_f32_bf16 v9, s67, v89
    v_dot2c_f32_bf16 v8, s67, v74
    v_dot2c_f32_bf16 v9, s67, v90
    v_dot2c_f32_bf16 v8, s67, v75
    v_dot2c_f32_bf16 v9, s67, v91
    v_dot2c_f32_bf16 v10, s67, v128
    v_dot2c_f32_bf16 v11, v128, v128
    buffer_load_dwordx4 v255, s[12:15], s60 offen offset:1024 lds
    v_dot2c_f32_bf16 v10, s67, v129
    v_dot2c_f32_bf16 v11, v129, v129
    v_dot2c_f32_bf16 v10, s67, v130
    v_dot2c_f32_bf16 v11, v130, v130
    v_dot2c_f32_bf16 v10, s67, v131
    v_dot2c_f32_bf16 v11, v131, v131
    v_dot2c_f32_bf16 v10, s67, v132
    v_dot2c_f32_bf16 v11, v132, v132
    v_dot2c_f32_bf16 v10, s67, v133
    v_dot2c_f32_bf16 v11, v133, v133
    v_dot2c_f32_bf16 v10, s67, v134
    v_dot2c_f32_bf16 v11, v134, v134
    v_dot2c_f32_bf16 v10, s67, v135
    v_dot2c_f32_bf16 v11, v135, v135
    s_waitcnt vmcnt(6) lgkmcnt(0)
    s_barrier
    v_mfma_f32_32x32x16_bf16 v[16:31], v[96:99], v[136:139], v[16:31]
    ds_read_b128 v[144:147], v240 offset:16384
    ds_read_b64_tr_b16 v[64:65], v244 offset:16384
    s_add_u32 s71, s70, 4
    s_and_b32 s71, s71, 7
    s_lshl_b32 s60, s71, 7
    s_add_u32 m0, s66, 81920
    s_add_u32 s60, s60, s68
    buffer_load_dwordx4 v252, s[8:11], s60 offen lds
    v_mfma_f32_32x32x16_bf16 v[32:47], v[112:115], v[136:139], v[32:47]
    ds_read_b64_tr_b16 v[66:67], v244 offset:16896
    ds_read_b64_tr_b16 v[80:81], v248 offset:16384
    v_mfma_f32_32x32x16_bf16 v[16:31], v[100:103], v[140:143], v[16:31]
    ds_read_b64_tr_b16 v[82:83], v248 offset:16896
    ds_read_b128 v[148:151], v241 offset:16384
    buffer_load_dwordx4 v253, s[8:11], s60 offen offset:1024 lds
    v_mfma_f32_32x32x16_bf16 v[32:47], v[116:119], v[140:143], v[32:47]
    ds_read_b64_tr_b16 v[68:69], v245 offset:16384
    ds_read_b64_tr_b16 v[70:71], v245 offset:16896
    v_mfma_f32_32x32x16_bf16 v[16:31], v[104:107], a[8:11], v[16:31]
    ds_read_b64_tr_b16 v[84:85], v249 offset:16384
    ds_read_b64_tr_b16 v[86:87], v249 offset:16896
    s_mul_i32 s71, s71, 196608
    s_add_u32 s71, s71, s69
    s_nop 0
    s_add_u32 m0, s66, 8192
    s_add_u32 s60, s71, 1024
    buffer_load_dwordx4 v254, s[12:15], s60 offen lds
    v_mfma_f32_32x32x16_bf16 v[32:47], v[120:123], a[8:11], v[32:47]
    ds_read_b128 a[16:19], v242 offset:16384
    ds_read_b64_tr_b16 v[72:73], v246 offset:16384
    v_mfma_f32_32x32x16_bf16 v[16:31], v[108:111], a[12:15], v[16:31]
    ds_read_b64_tr_b16 v[74:75], v246 offset:16896
    ds_read_b64_tr_b16 v[88:89], v250 offset:16384
    buffer_load_dwordx4 v255, s[12:15], s60 offen offset:1024 lds
    v_mfma_f32_32x32x16_bf16 v[32:47], v[124:127], a[12:15], v[32:47]
    ds_read_b64_tr_b16 v[90:91], v250 offset:16896
    ds_read_b128 a[20:23], v243 offset:16384
    ds_read_b64_tr_b16 v[4:5], v56
    ds_read_b64_tr_b16 v[6:7], v56 offset:256
    ds_read_b64_tr_b16 v[76:77], v247 offset:16384
    s_add_u32 m0, s66, 32768
    s_add_u32 s60, s71, 2048
    buffer_load_dwordx4 v254, s[12:15], s60 offen lds
    v_dot2c_f32_bf16 v8, s67, v96
    v_dot2c_f32_bf16 v9, s67, v112
    ds_read_b64_tr_b16 v[78:79], v247 offset:16896
    v_dot2c_f32_bf16 v8, s67, v97
    v_dot2c_f32_bf16 v9, s67, v113
    ds_read_b64_tr_b16 v[92:93], v251 offset:16384
    v_dot2c_f32_bf16 v8, s67, v98
    v_dot2c_f32_bf16 v9, s67, v114
    ds_read_b64_tr_b16 v[94:95], v251 offset:16896
    v_dot2c_f32_bf16 v8, s67, v99
    v_dot2c_f32_bf16 v9, s67, v115
    v_dot2c_f32_bf16 v8, s67, v104
    v_dot2c_f32_bf16 v9, s67, v120
    v_dot2c_f32_bf16 v8, s67, v105
    v_dot2c_f32_bf16 v9, s67, v121
    v_dot2c_f32_bf16 v8, s67, v106
    v_dot2c_f32_bf16 v9, s67, v122
    v_dot2c_f32_bf16 v8, s67, v107
    v_dot2c_f32_bf16 v9, s67, v123
    v_dot2c_f32_bf16 v10, s67, v136
    v_dot2c_f32_bf16 v11, v136, v136
    buffer_load_dwordx4 v255, s[12:15], s60 offen offset:1024 lds
    v_dot2c_f32_bf16 v10, s67, v137
    v_dot2c_f32_bf16 v11, v137, v137
    v_dot2c_f32_bf16 v10, s67, v138
    v_dot2c_f32_bf16 v11, v138, v138
    v_dot2c_f32_bf16 v10, s67, v139
    v_dot2c_f32_bf16 v11, v139, v139
    v_dot2c_f32_bf16 v10, s67, v140
    v_dot2c_f32_bf16 v11, v140, v140
    v_dot2c_f32_bf16 v10, s67, v141
    v_dot2c_f32_bf16 v11, v141, v141
    v_dot2c_f32_bf16 v10, s67, v142
    v_dot2c_f32_bf16 v11, v142, v142
    v_dot2c_f32_bf16 v10, s67, v143
    v_dot2c_f32_bf16 v11, v143, v143
    s_xor_b32 s61, s48, 2
    s_mul_i32 s61, s61, 12288
    s_add_u32 s61, s61, 4096
    v_add_u32 v210, s61, v3
    s_xor_b32 s61, s48, 3
    s_mul_i32 s61, s61, 12288
    s_add_u32 s61, s61, 8192
    v_add_u32 v211, s61, v3
    s_mul_i32 s61, s48, 12288
    v_add_u32 v212, s61, v3
    v_lshlrev_b32 v14, 10, v1
    v_lshl_add_u32 v215, v2, 4, v14
    v_lshlrev_b32 v216, 3, v1
    v_lshl_add_u32 v217, v2, 11, v216
    v_lshlrev_b32 v222, 3, v2
    v_lshlrev_b32 v223, 1, v1
    s_lshl_b32 s63, s48, 11
    s_add_u32 s63, s63, 49152
    v_lshrrev_b32 v14, 2, v0
    v_bfe_u32 v15, v0, 3, 2
    v_xor_b32 v15, v15, v0
    v_and_b32 v15, 3, v15
    v_lshlrev_b32 v15, 4, v15
    v_lshl_add_u32 v213, v14, 10, v15
    v_bfe_u32 v14, v1, 1, 2
    v_lshlrev_b32 v14, 4, v14
    v_lshl_add_u32 v14, v1, 6, v14
    v_lshl_add_u32 v14, v2, 3, v14
    v_add_u32 v214, s63, v14
    v_add_u32 v218, s63, v218
    v_xor_b32 v219, 16, v218
    v_add_u32 v220, s63, v220
    v_add_u32 v221, s63, v221
    s_lshl3_add_u32 s61, s56, s54
    s_lshl1_add_u32 s61, s61, s59
    s_lshl1_add_u32 s61, s61, s58
    s_lshl_b32 s61, s61, 11
    s_add_u32 s5, s61, 6291456
    s_lshl1_add_u32 s61, s49, s59
    s_lshl_b32 s61, s61, 15
    s_lshl1_add_u32 s63, s50, s58
    s_lshl_b32 s63, s63, 6
    s_add_u32 s6, s61, s63
    s_waitcnt vmcnt(6) lgkmcnt(0)
    s_barrier
    v_mfma_f32_32x32x16_bf16 v[16:31], v[64:67], v[144:147], v[16:31]
    ds_read_b128 v[152:155], v240 offset:0
    ds_read_b64_tr_b16 v[96:97], v244 offset:0
    s_add_u32 s71, s70, 5
    s_and_b32 s71, s71, 7
    s_lshl_b32 s60, s71, 7
    s_add_u32 m0, s66, 90112
    s_add_u32 s60, s60, s68
    s_nop 0
    buffer_load_dwordx4 v252, s[8:11], s60 offen lds
    v_mfma_f32_32x32x16_bf16 v[32:47], v[80:83], v[144:147], v[32:47]
    ds_read_b64_tr_b16 v[98:99], v244 offset:512
    ds_read_b64_tr_b16 v[112:113], v248 offset:0
    v_mfma_f32_32x32x16_bf16 v[16:31], v[68:71], v[148:151], v[16:31]
    ds_read_b64_tr_b16 v[114:115], v248 offset:512
    ds_read_b128 v[156:159], v241 offset:0
    buffer_load_dwordx4 v253, s[8:11], s60 offen offset:1024 lds
    v_mfma_f32_32x32x16_bf16 v[32:47], v[84:87], v[148:151], v[32:47]
    ds_read_b64_tr_b16 v[100:101], v245 offset:0
    ds_read_b64_tr_b16 v[102:103], v245 offset:512
    v_mfma_f32_32x32x16_bf16 v[16:31], v[72:75], a[16:19], v[16:31]
    ds_read_b64_tr_b16 v[116:117], v249 offset:0
    ds_read_b64_tr_b16 v[118:119], v249 offset:512
    s_mul_i32 s71, s71, 196608
    s_add_u32 s71, s71, s69
    s_nop 0
    s_add_u32 m0, s66, 16384
    s_add_u32 s60, s71, 1024
    buffer_load_dwordx4 v254, s[12:15], s60 offen lds
    v_mfma_f32_32x32x16_bf16 v[32:47], v[88:91], a[16:19], v[32:47]
    ds_read_b128 a[24:27], v242 offset:0
    ds_read_b64_tr_b16 v[104:105], v246 offset:0
    v_mfma_f32_32x32x16_bf16 v[16:31], v[76:79], a[20:23], v[16:31]
    ds_read_b64_tr_b16 v[106:107], v246 offset:512
    ds_read_b64_tr_b16 v[120:121], v250 offset:0
    buffer_load_dwordx4 v255, s[12:15], s60 offen offset:1024 lds
    v_mfma_f32_32x32x16_bf16 v[32:47], v[92:95], a[20:23], v[32:47]
    ds_read_b64_tr_b16 v[122:123], v250 offset:512
    ds_read_b128 a[28:31], v243 offset:0
    ds_read_b64_tr_b16 v[108:109], v247 offset:0
    s_add_u32 m0, s66, 40960
    s_add_u32 s60, s71, 2048
    buffer_load_dwordx4 v254, s[12:15], s60 offen lds
    v_dot2c_f32_bf16 v8, s67, v64
    v_dot2c_f32_bf16 v9, s67, v80
    ds_read_b64_tr_b16 v[110:111], v247 offset:512
    v_dot2c_f32_bf16 v8, s67, v65
    v_dot2c_f32_bf16 v9, s67, v81
    ds_read_b64_tr_b16 v[124:125], v251 offset:0
    v_dot2c_f32_bf16 v8, s67, v66
    v_dot2c_f32_bf16 v9, s67, v82
    ds_read_b64_tr_b16 v[126:127], v251 offset:512
    v_dot2c_f32_bf16 v8, s67, v67
    v_dot2c_f32_bf16 v9, s67, v83
    v_dot2c_f32_bf16 v8, s67, v72
    v_dot2c_f32_bf16 v9, s67, v88
    v_dot2c_f32_bf16 v8, s67, v73
    v_dot2c_f32_bf16 v9, s67, v89
    v_dot2c_f32_bf16 v8, s67, v74
    v_dot2c_f32_bf16 v9, s67, v90
    v_dot2c_f32_bf16 v8, s67, v75
    v_dot2c_f32_bf16 v9, s67, v91
    v_dot2c_f32_bf16 v10, s67, v144
    v_dot2c_f32_bf16 v11, v144, v144
    buffer_load_dwordx4 v255, s[12:15], s60 offen offset:1024 lds
    v_dot2c_f32_bf16 v10, s67, v145
    v_dot2c_f32_bf16 v11, v145, v145
    v_dot2c_f32_bf16 v10, s67, v146
    v_dot2c_f32_bf16 v11, v146, v146
    v_dot2c_f32_bf16 v10, s67, v147
    v_dot2c_f32_bf16 v11, v147, v147
    v_dot2c_f32_bf16 v10, s67, v148
    v_dot2c_f32_bf16 v11, v148, v148
    v_dot2c_f32_bf16 v10, s67, v149
    v_dot2c_f32_bf16 v11, v149, v149
    v_dot2c_f32_bf16 v10, s67, v150
    v_dot2c_f32_bf16 v11, v150, v150
    v_dot2c_f32_bf16 v10, s67, v151
    v_dot2c_f32_bf16 v11, v151, v151
    s_waitcnt vmcnt(6) lgkmcnt(0)
    s_barrier
    v_mfma_f32_32x32x16_bf16 v[16:31], v[96:99], v[152:155], v[16:31]
    ds_read_b128 v[160:163], v240 offset:8192
    ds_read_b64_tr_b16 v[64:65], v244 offset:8192
    s_add_u32 s71, s70, 6
    s_and_b32 s71, s71, 7
    s_lshl_b32 s60, s71, 7
    s_add_u32 m0, s66, 73728
    s_add_u32 s60, s60, s68
    buffer_load_dwordx4 v252, s[8:11], s60 offen lds
    v_mfma_f32_32x32x16_bf16 v[32:47], v[112:115], v[152:155], v[32:47]
    ds_read_b64_tr_b16 v[66:67], v244 offset:8704
    ds_read_b64_tr_b16 v[80:81], v248 offset:8192
    v_mfma_f32_32x32x16_bf16 v[16:31], v[100:103], v[156:159], v[16:31]
    ds_read_b64_tr_b16 v[82:83], v248 offset:8704
    ds_read_b128 v[164:167], v241 offset:8192
    buffer_load_dwordx4 v253, s[8:11], s60 offen offset:1024 lds
    v_mfma_f32_32x32x16_bf16 v[32:47], v[116:119], v[156:159], v[32:47]
    ds_read_b64_tr_b16 v[68:69], v245 offset:8192
    ds_read_b64_tr_b16 v[70:71], v245 offset:8704
    v_mfma_f32_32x32x16_bf16 v[16:31], v[104:107], a[24:27], v[16:31]
    ds_read_b64_tr_b16 v[84:85], v249 offset:8192
    ds_read_b64_tr_b16 v[86:87], v249 offset:8704
    s_mul_i32 s71, s71, 196608
    s_add_u32 s71, s71, s69
    s_add_u32 m0, s66, 0
    s_add_u32 s60, s71, 1024
    buffer_load_dwordx4 v254, s[12:15], s60 offen lds
    v_mfma_f32_32x32x16_bf16 v[32:47], v[120:123], a[24:27], v[32:47]
    ds_read_b128 a[32:35], v242 offset:8192
    ds_read_b64_tr_b16 v[72:73], v246 offset:8192
    v_mfma_f32_32x32x16_bf16 v[16:31], v[108:111], a[28:31], v[16:31]
    ds_read_b64_tr_b16 v[74:75], v246 offset:8704
    ds_read_b64_tr_b16 v[88:89], v250 offset:8192
    buffer_load_dwordx4 v255, s[12:15], s60 offen offset:1024 lds
    v_mfma_f32_32x32x16_bf16 v[32:47], v[124:127], a[28:31], v[32:47]
    ds_read_b64_tr_b16 v[90:91], v250 offset:8704
    ds_read_b128 a[36:39], v243 offset:8192
    ds_read_b64_tr_b16 v[76:77], v247 offset:8192
    s_add_u32 m0, s66, 24576
    s_add_u32 s60, s71, 2048
    buffer_load_dwordx4 v254, s[12:15], s60 offen lds
    v_dot2c_f32_bf16 v8, s67, v96
    v_dot2c_f32_bf16 v9, s67, v112
    ds_read_b64_tr_b16 v[78:79], v247 offset:8704
    v_dot2c_f32_bf16 v8, s67, v97
    v_dot2c_f32_bf16 v9, s67, v113
    ds_read_b64_tr_b16 v[92:93], v251 offset:8192
    v_dot2c_f32_bf16 v8, s67, v98
    v_dot2c_f32_bf16 v9, s67, v114
    ds_read_b64_tr_b16 v[94:95], v251 offset:8704
    v_dot2c_f32_bf16 v8, s67, v99
    v_dot2c_f32_bf16 v9, s67, v115
    v_dot2c_f32_bf16 v8, s67, v104
    v_dot2c_f32_bf16 v9, s67, v120
    v_dot2c_f32_bf16 v8, s67, v105
    v_dot2c_f32_bf16 v9, s67, v121
    v_dot2c_f32_bf16 v8, s67, v106
    v_dot2c_f32_bf16 v9, s67, v122
    v_dot2c_f32_bf16 v8, s67, v107
    v_dot2c_f32_bf16 v9, s67, v123
    v_dot2c_f32_bf16 v10, s67, v152
    v_dot2c_f32_bf16 v11, v152, v152
    buffer_load_dwordx4 v255, s[12:15], s60 offen offset:1024 lds
    v_dot2c_f32_bf16 v10, s67, v153
    v_dot2c_f32_bf16 v11, v153, v153
    v_dot2c_f32_bf16 v10, s67, v154
    v_dot2c_f32_bf16 v11, v154, v154
    v_dot2c_f32_bf16 v10, s67, v155
    v_dot2c_f32_bf16 v11, v155, v155
    v_dot2c_f32_bf16 v10, s67, v156
    v_dot2c_f32_bf16 v11, v156, v156
    v_dot2c_f32_bf16 v10, s67, v157
    v_dot2c_f32_bf16 v11, v157, v157
    v_dot2c_f32_bf16 v10, s67, v158
    v_dot2c_f32_bf16 v11, v158, v158
    v_dot2c_f32_bf16 v10, s67, v159
    v_dot2c_f32_bf16 v11, v159, v159
    s_waitcnt vmcnt(6) lgkmcnt(0)
    s_barrier
    v_mfma_f32_32x32x16_bf16 v[16:31], v[64:67], v[160:163], v[16:31]
    ds_read_b128 v[168:171], v240 offset:16384
    ds_read_b64_tr_b16 v[96:97], v244 offset:16384
    s_add_u32 s71, s70, 7
    s_and_b32 s71, s71, 7
    s_lshl_b32 s60, s71, 7
    s_add_u32 m0, s66, 81920
    s_add_u32 s60, s60, s68
    buffer_load_dwordx4 v252, s[8:11], s60 offen lds
    v_mfma_f32_32x32x16_bf16 v[32:47], v[80:83], v[160:163], v[32:47]
    ds_read_b64_tr_b16 v[98:99], v244 offset:16896
    ds_read_b64_tr_b16 v[112:113], v248 offset:16384
    buffer_load_dwordx4 v253, s[8:11], s60 offen offset:1024 lds
    v_mfma_f32_32x32x16_bf16 v[16:31], v[68:71], v[164:167], v[16:31]
    ds_read_b64_tr_b16 v[114:115], v248 offset:16896
    ds_read_b128 v[172:175], v241 offset:16384
    s_mul_i32 s71, s71, 196608
    s_add_u32 s71, s71, s69
    s_nop 0
    s_add_u32 m0, s66, 8192
    s_add_u32 s60, s71, 1024
    buffer_load_dwordx4 v254, s[12:15], s60 offen lds
    v_mfma_f32_32x32x16_bf16 v[32:47], v[84:87], v[164:167], v[32:47]
    ds_read_b64_tr_b16 v[100:101], v245 offset:16384
    ds_read_b64_tr_b16 v[102:103], v245 offset:16896
    buffer_load_dwordx4 v255, s[12:15], s60 offen offset:1024 lds
    v_mfma_f32_32x32x16_bf16 v[16:31], v[72:75], a[32:35], v[16:31]
    ds_read_b64_tr_b16 v[116:117], v249 offset:16384
    ds_read_b64_tr_b16 v[118:119], v249 offset:16896
    s_add_u32 m0, s66, 32768
    s_add_u32 s60, s71, 2048
    buffer_load_dwordx4 v254, s[12:15], s60 offen lds
    v_mfma_f32_32x32x16_bf16 v[32:47], v[88:91], a[32:35], v[32:47]
    ds_read_b128 a[40:43], v242 offset:16384
    ds_read_b64_tr_b16 v[104:105], v246 offset:16384
    buffer_load_dwordx4 v255, s[12:15], s60 offen offset:1024 lds
    v_mfma_f32_32x32x16_bf16 v[16:31], v[76:79], a[36:39], v[16:31]
    ds_read_b64_tr_b16 v[106:107], v246 offset:16896
    ds_read_b64_tr_b16 v[120:121], v250 offset:16384
    s_add_u32 s71, s70, 0
    s_and_b32 s71, s71, 7
    s_mul_i32 s71, s71, 196608
    s_add_u32 s71, s71, s69
    s_add_u32 m0, s66, 98304
    s_mov_b32 s60, s71
    buffer_load_dwordx4 v254, s[12:15], s60 offen lds
    v_mfma_f32_32x32x16_bf16 v[32:47], v[92:95], a[36:39], v[32:47]
    ds_read_b64_tr_b16 v[122:123], v250 offset:16896
    ds_read_b128 a[44:47], v243 offset:16384
    buffer_load_dwordx4 v255, s[12:15], s60 offen offset:1024 lds
    ds_read_b64_tr_b16 v[108:109], v247 offset:16384
    s_add_u32 s71, s70, 1
    s_and_b32 s71, s71, 7
    s_mul_i32 s71, s71, 196608
    s_add_u32 s71, s71, s69
    s_add_u32 m0, s66, 106496
    s_mov_b32 s60, s71
    buffer_load_dwordx4 v254, s[12:15], s60 offen lds
    v_dot2c_f32_bf16 v8, s67, v64
    v_dot2c_f32_bf16 v9, s67, v80
    ds_read_b64_tr_b16 v[110:111], v247 offset:16896
    v_dot2c_f32_bf16 v8, s67, v65
    v_dot2c_f32_bf16 v9, s67, v81
    ds_read_b64_tr_b16 v[124:125], v251 offset:16384
    v_dot2c_f32_bf16 v8, s67, v66
    v_dot2c_f32_bf16 v9, s67, v82
    ds_read_b64_tr_b16 v[126:127], v251 offset:16896
    v_dot2c_f32_bf16 v8, s67, v67
    v_dot2c_f32_bf16 v9, s67, v83
    v_dot2c_f32_bf16 v8, s67, v72
    v_dot2c_f32_bf16 v9, s67, v88
    v_dot2c_f32_bf16 v8, s67, v73
    v_dot2c_f32_bf16 v9, s67, v89
    v_dot2c_f32_bf16 v8, s67, v74
    v_dot2c_f32_bf16 v9, s67, v90
    v_dot2c_f32_bf16 v8, s67, v75
    v_dot2c_f32_bf16 v9, s67, v91
    v_dot2c_f32_bf16 v10, s67, v160
    v_dot2c_f32_bf16 v11, v160, v160
    buffer_load_dwordx4 v255, s[12:15], s60 offen offset:1024 lds
    v_dot2c_f32_bf16 v10, s67, v161
    v_dot2c_f32_bf16 v11, v161, v161
    v_dot2c_f32_bf16 v10, s67, v162
    v_dot2c_f32_bf16 v11, v162, v162
    v_dot2c_f32_bf16 v10, s67, v163
    v_dot2c_f32_bf16 v11, v163, v163
    v_dot2c_f32_bf16 v10, s67, v164
    v_dot2c_f32_bf16 v11, v164, v164
    v_dot2c_f32_bf16 v10, s67, v165
    v_dot2c_f32_bf16 v11, v165, v165
    v_dot2c_f32_bf16 v10, s67, v166
    v_dot2c_f32_bf16 v11, v166, v166
    v_dot2c_f32_bf16 v10, s67, v167
    v_dot2c_f32_bf16 v11, v167, v167
    s_waitcnt vmcnt(10) lgkmcnt(0)
    s_barrier
    v_mfma_f32_32x32x16_bf16 v[16:31], v[96:99], v[168:171], v[16:31]
    ds_read_b128 v[176:179], v240 offset:0
    ds_read_b64_tr_b16 v[64:65], v244 offset:0
    s_add_u32 s71, s70, 2
    s_and_b32 s71, s71, 7
    s_mul_i32 s71, s71, 196608
    s_add_u32 s71, s71, s69
    s_add_u32 m0, s66, 114688
    s_mov_b32 s60, s71
    buffer_load_dwordx4 v254, s[12:15], s60 offen lds
    v_mfma_f32_32x32x16_bf16 v[32:47], v[112:115], v[168:171], v[32:47]
    ds_read_b64_tr_b16 v[66:67], v244 offset:512
    ds_read_b64_tr_b16 v[80:81], v248 offset:0
    v_mfma_f32_32x32x16_bf16 v[16:31], v[100:103], v[172:175], v[16:31]
    ds_read_b64_tr_b16 v[82:83], v248 offset:512
    ds_read_b128 v[180:183], v241 offset:0
    buffer_load_dwordx4 v255, s[12:15], s60 offen offset:1024 lds
    v_mfma_f32_32x32x16_bf16 v[32:47], v[116:119], v[172:175], v[32:47]
    ds_read_b64_tr_b16 v[68:69], v245 offset:0
    ds_read_b64_tr_b16 v[70:71], v245 offset:512
    s_add_u32 s71, s70, 3
    s_and_b32 s71, s71, 7
    s_mul_i32 s71, s71, 196608
    s_add_u32 s71, s71, s69
    s_add_u32 m0, s66, 122880
    s_mov_b32 s60, s71
    buffer_load_dwordx4 v254, s[12:15], s60 offen lds
    v_mfma_f32_32x32x16_bf16 v[16:31], v[104:107], a[40:43], v[16:31]
    ds_read_b64_tr_b16 v[84:85], v249 offset:0
    ds_read_b64_tr_b16 v[86:87], v249 offset:512
    v_mfma_f32_32x32x16_bf16 v[32:47], v[120:123], a[40:43], v[32:47]
    ds_read_b128 a[48:51], v242 offset:0
    ds_read_b64_tr_b16 v[72:73], v246 offset:0
    buffer_load_dwordx4 v255, s[12:15], s60 offen offset:1024 lds
    v_mfma_f32_32x32x16_bf16 v[16:31], v[108:111], a[44:47], v[16:31]
    ds_read_b64_tr_b16 v[74:75], v246 offset:512
    ds_read_b64_tr_b16 v[88:89], v250 offset:0
    s_add_u32 s71, s70, 4
    s_and_b32 s71, s71, 7
    s_mul_i32 s71, s71, 196608
    s_add_u32 s71, s71, s69
    s_add_u32 m0, s66, 131072
    s_mov_b32 s60, s71
    buffer_load_dwordx4 v254, s[12:15], s60 offen lds
    v_mfma_f32_32x32x16_bf16 v[32:47], v[124:127], a[44:47], v[32:47]
    ds_read_b64_tr_b16 v[90:91], v250 offset:512
    ds_read_b128 a[52:55], v243 offset:0
    ds_read_b64_tr_b16 v[76:77], v247 offset:0
    buffer_load_dwordx4 v255, s[12:15], s60 offen offset:1024 lds
    v_dot2c_f32_bf16 v8, s67, v96
    v_dot2c_f32_bf16 v9, s67, v112
    ds_read_b64_tr_b16 v[78:79], v247 offset:512
    v_dot2c_f32_bf16 v8, s67, v97
    v_dot2c_f32_bf16 v9, s67, v113
    ds_read_b64_tr_b16 v[92:93], v251 offset:0
    v_dot2c_f32_bf16 v8, s67, v98
    v_dot2c_f32_bf16 v9, s67, v114
    ds_read_b64_tr_b16 v[94:95], v251 offset:512
    v_dot2c_f32_bf16 v8, s67, v99
    v_dot2c_f32_bf16 v9, s67, v115
    v_dot2c_f32_bf16 v8, s67, v104
    v_dot2c_f32_bf16 v9, s67, v120
    v_dot2c_f32_bf16 v8, s67, v105
    v_dot2c_f32_bf16 v9, s67, v121
    v_dot2c_f32_bf16 v8, s67, v106
    v_dot2c_f32_bf16 v9, s67, v122
    v_dot2c_f32_bf16 v8, s67, v107
    v_dot2c_f32_bf16 v9, s67, v123
    v_dot2c_f32_bf16 v10, s67, v168
    v_dot2c_f32_bf16 v11, v168, v168
    s_cmp_eq_u32 s48, 0
    s_cselect_b32 s63, s73, 16777216
    s_mov_b64 exec, 0xff
    buffer_store_dwordx4 v[52:55], v3, s[16:19], s63 offen sc1
    s_and_b32 s61, s63, 0xfffffe00
    s_bitcmp0_b32 s49, 0
    s_cselect_b32 s61, s61, 16777216
    buffer_store_dwordx4 v[52:55], v3, s[16:19], s61 offen offset:256 sc1
    s_mov_b64 exec, -1
    v_dot2c_f32_bf16 v10, s67, v169
    v_dot2c_f32_bf16 v11, v169, v169
    v_dot2c_f32_bf16 v10, s67, v170
    v_dot2c_f32_bf16 v11, v170, v170
    v_dot2c_f32_bf16 v10, s67, v171
    v_dot2c_f32_bf16 v11, v171, v171
    v_dot2c_f32_bf16 v10, s67, v172
    v_dot2c_f32_bf16 v11, v172, v172
    v_dot2c_f32_bf16 v10, s67, v173
    v_dot2c_f32_bf16 v11, v173, v173
    v_dot2c_f32_bf16 v10, s67, v174
    v_dot2c_f32_bf16 v11, v174, v174
    v_dot2c_f32_bf16 v10, s67, v175
    v_dot2c_f32_bf16 v11, v175, v175
    s_waitcnt vmcnt(12) lgkmcnt(0)
    s_barrier
    v_mfma_f32_32x32x16_bf16 v[16:31], v[64:67], v[176:179], v[16:31]
    ds_read_b128 v[184:187], v240 offset:8192
    ds_read_b64_tr_b16 v[96:97], v244 offset:8192
    s_add_u32 s71, s70, 5
    s_and_b32 s71, s71, 7
    s_mul_i32 s71, s71, 196608
    s_add_u32 s71, s71, s69
    s_add_u32 m0, s66, 139264
    s_mov_b32 s60, s71
    s_nop 0
    buffer_load_dwordx4 v254, s[12:15], s60 offen lds
    v_mfma_f32_32x32x16_bf16 v[32:47], v[80:83], v[176:179], v[32:47]
    ds_read_b64_tr_b16 v[98:99], v244 offset:8704
    ds_read_b64_tr_b16 v[112:113], v248 offset:8192
    v_mfma_f32_32x32x16_bf16 v[16:31], v[68:71], v[180:183], v[16:31]
    ds_read_b64_tr_b16 v[114:115], v248 offset:8704
    ds_read_b128 v[188:191], v241 offset:8192
    buffer_load_dwordx4 v255, s[12:15], s60 offen offset:1024 lds
    v_mfma_f32_32x32x16_bf16 v[32:47], v[84:87], v[180:183], v[32:47]
    ds_read_b64_tr_b16 v[100:101], v245 offset:8192
    ds_read_b64_tr_b16 v[102:103], v245 offset:8704
    v_mfma_f32_32x32x16_bf16 v[16:31], v[72:75], a[48:51], v[16:31]
    ds_read_b64_tr_b16 v[116:117], v249 offset:8192
    ds_read_b64_tr_b16 v[118:119], v249 offset:8704
    s_add_u32 s71, s70, 6
    s_and_b32 s71, s71, 7
    s_mul_i32 s71, s71, 196608
    s_add_u32 s71, s71, s69
    s_add_u32 m0, s66, 147456
    s_mov_b32 s60, s71
    buffer_load_dwordx4 v254, s[12:15], s60 offen lds
    v_mfma_f32_32x32x16_bf16 v[32:47], v[88:91], a[48:51], v[32:47]
    ds_read_b128 a[56:59], v242 offset:8192
    ds_read_b64_tr_b16 v[104:105], v246 offset:8192
    v_mfma_f32_32x32x16_bf16 v[16:31], v[76:79], a[52:55], v[16:31]
    ds_read_b64_tr_b16 v[106:107], v246 offset:8704
    ds_read_b64_tr_b16 v[120:121], v250 offset:8192
    buffer_load_dwordx4 v255, s[12:15], s60 offen offset:1024 lds
    v_mfma_f32_32x32x16_bf16 v[32:47], v[92:95], a[52:55], v[32:47]
    ds_read_b64_tr_b16 v[122:123], v250 offset:8704
    ds_read_b128 a[60:63], v243 offset:8192
    ds_read_b64_tr_b16 v[108:109], v247 offset:8192
    s_add_u32 s71, s70, 7
    s_and_b32 s71, s71, 7
    s_mul_i32 s71, s71, 196608
    s_add_u32 s71, s71, s69
    s_add_u32 m0, s66, 155648
    s_mov_b32 s60, s71
    buffer_load_dwordx4 v254, s[12:15], s60 offen lds
    v_dot2c_f32_bf16 v8, s67, v64
    v_dot2c_f32_bf16 v9, s67, v80
    ds_read_b64_tr_b16 v[110:111], v247 offset:8704
    v_dot2c_f32_bf16 v8, s67, v65
    v_dot2c_f32_bf16 v9, s67, v81
    ds_read_b64_tr_b16 v[124:125], v251 offset:8192
    v_dot2c_f32_bf16 v8, s67, v66
    v_dot2c_f32_bf16 v9, s67, v82
    ds_read_b64_tr_b16 v[126:127], v251 offset:8704
    v_dot2c_f32_bf16 v8, s67, v67
    v_dot2c_f32_bf16 v9, s67, v83
    v_dot2c_f32_bf16 v8, s67, v72
    v_dot2c_f32_bf16 v9, s67, v88
    v_dot2c_f32_bf16 v8, s67, v73
    v_dot2c_f32_bf16 v9, s67, v89
    v_dot2c_f32_bf16 v8, s67, v74
    v_dot2c_f32_bf16 v9, s67, v90
    v_dot2c_f32_bf16 v8, s67, v75
    v_dot2c_f32_bf16 v9, s67, v91
    v_dot2c_f32_bf16 v10, s67, v176
    v_dot2c_f32_bf16 v11, v176, v176
    buffer_load_dwordx4 v255, s[12:15], s60 offen offset:1024 lds
    v_dot2c_f32_bf16 v10, s67, v177
    v_dot2c_f32_bf16 v11, v177, v177
    v_dot2c_f32_bf16 v10, s67, v178
    v_dot2c_f32_bf16 v11, v178, v178
    v_dot2c_f32_bf16 v10, s67, v179
    v_dot2c_f32_bf16 v11, v179, v179
    v_dot2c_f32_bf16 v10, s67, v180
    v_dot2c_f32_bf16 v11, v180, v180
    v_dot2c_f32_bf16 v10, s67, v181
    v_dot2c_f32_bf16 v11, v181, v181
    v_dot2c_f32_bf16 v10, s67, v182
    v_dot2c_f32_bf16 v11, v182, v182
    v_dot2c_f32_bf16 v10, s67, v183
    v_dot2c_f32_bf16 v11, v183, v183
    s_waitcnt lgkmcnt(0)
    v_mfma_f32_32x32x16_bf16 v[16:31], v[96:99], v[184:187], v[16:31]
    s_lshl2_add_u32 s60, s2, s48
    s_lshl_b32 s60, s60, 9
    s_mov_b32 exec_hi, 0
    buffer_load_dwordx4 v[52:55], v3, s[20:23], s60 offen
    s_mov_b64 exec, -1
    v_mfma_f32_32x32x16_bf16 v[32:47], v[112:115], v[184:187], v[32:47]
    v_mfma_f32_32x32x16_bf16 v[16:31], v[100:103], v[188:191], v[16:31]
    s_add_u32 s60, s98, 0
    buffer_load_dwordx4 v[52:55], v226, s[24:27], s60 offen
    v_mfma_f32_32x32x16_bf16 v[32:47], v[116:119], v[188:191], v[32:47]
    v_mfma_f32_32x32x16_bf16 v[16:31], v[104:107], a[56:59], v[16:31]
    s_add_u32 s60, s98, 229376
    buffer_load_dwordx4 v[52:55], v226, s[24:27], s60 offen
    v_mfma_f32_32x32x16_bf16 v[32:47], v[120:123], a[56:59], v[32:47]
    v_mfma_f32_32x32x16_bf16 v[16:31], v[108:111], a[60:63], v[16:31]
    s_add_u32 s60, s98, 458752
    buffer_load_dwordx4 v[52:55], v226, s[24:27], s60 offen
    v_mfma_f32_32x32x16_bf16 v[32:47], v[124:127], a[60:63], v[32:47]
    s_add_u32 s60, s98, 688128
    buffer_load_dwordx4 v[52:55], v226, s[24:27], s60 offen
    v_dot2c_f32_bf16 v8, s67, v96
    v_dot2c_f32_bf16 v9, s67, v112
    v_dot2c_f32_bf16 v8, s67, v97
    v_dot2c_f32_bf16 v9, s67, v113
    v_dot2c_f32_bf16 v8, s67, v98
    v_dot2c_f32_bf16 v9, s67, v114
    v_dot2c_f32_bf16 v8, s67, v99
    v_dot2c_f32_bf16 v9, s67, v115
    v_dot2c_f32_bf16 v8, s67, v104
    v_dot2c_f32_bf16 v9, s67, v120
    v_dot2c_f32_bf16 v8, s67, v105
    v_dot2c_f32_bf16 v9, s67, v121
    v_dot2c_f32_bf16 v8, s67, v106
    v_dot2c_f32_bf16 v9, s67, v122
    v_dot2c_f32_bf16 v8, s67, v107
    v_dot2c_f32_bf16 v9, s67, v123
    v_dot2c_f32_bf16 v10, s67, v184
    v_dot2c_f32_bf16 v11, v184, v184
    s_add_u32 s60, s98, 917504
    buffer_load_dwordx4 v[52:55], v226, s[24:27], s60 offen
    v_dot2c_f32_bf16 v10, s67, v185
    v_dot2c_f32_bf16 v11, v185, v185
    v_dot2c_f32_bf16 v10, s67, v186
    v_dot2c_f32_bf16 v11, v186, v186
    v_dot2c_f32_bf16 v10, s67, v187
    v_dot2c_f32_bf16 v11, v187, v187
    v_dot2c_f32_bf16 v10, s67, v188
    v_dot2c_f32_bf16 v11, v188, v188
    v_dot2c_f32_bf16 v10, s67, v189
    v_dot2c_f32_bf16 v11, v189, v189
    v_dot2c_f32_bf16 v10, s67, v190
    v_dot2c_f32_bf16 v11, v190, v190
    v_dot2c_f32_bf16 v10, s67, v191
    v_dot2c_f32_bf16 v11, v191, v191
    s_nop 2
    v_permlane32_swap_b32 v8, v9
    v_permlane32_swap_b32 v10, v11
    v_add_f32 v8, v8, v9
    v_add_f32 v10, v10, v11
    ds_write_b32 v59, v8
    ds_write_b32 v60, v10
    v_mov_b32 v14, s67
    v_mov_b32 v15, s67
    ds_write_b64 v57, v[14:15]
    v_cmp_gt_u32 vcc, 16, v1
    s_nop 1
    v_cndmask_b32 v48, 0, v4, vcc
    v_cndmask_b32 v49, 0, v5, vcc
    v_cndmask_b32 v50, 0, v6, vcc
    v_cndmask_b32 v51, 0, v7, vcc
    v_readfirstlane_b32 s53, v13
    s_waitcnt lgkmcnt(0)
    s_barrier
    ds_read2_b32 v[8:9], v62 offset0:0 offset1:64
    ds_read2_b32 v[10:11], v62 offset0:32 offset1:96
    ds_read_b128 v[64:67], v61 offset:0
    ds_read_b128 v[80:83], v61 offset:256
    ds_read_b128 v[68:71], v61 offset:32
    ds_read_b128 v[84:87], v61 offset:288
    ds_read_b128 v[72:75], v61 offset:64
    ds_read_b128 v[88:91], v61 offset:320
    ds_read_b128 v[76:79], v61 offset:96
    ds_read_b128 v[92:95], v61 offset:352
    v_sub_u32 v4, v4, v48
    v_sub_u32 v5, v5, v49
    v_sub_u32 v6, v6, v50
    v_sub_u32 v7, v7, v51
    s_mov_b32 s63, 0x3b000000
    s_waitcnt lgkmcnt(8)
    v_add_f32 v8, v8, v9
    v_add_f32_e64 v10, v10, v11
    v_mul_f32 v8, 0xbb000000, v8
    ds_read_b128 v[96:99], v61 offset:128
    ds_read_b128 v[112:115], v61 offset:384
    ds_read_b128 v[100:103], v61 offset:160
    ds_read_b128 v[116:119], v61 offset:416
    ds_read_b128 v[104:107], v61 offset:192
    ds_read_b128 v[120:123], v61 offset:448
    v_mul_f32 v15, v8, v8
    v_fma_f32 v15, v10, s63, -v15
    v_max_f32 v15, 0, v15
    v_add_f32 v15, 0x3727c5ac, v15
    v_rsq_f32 v10, v15
    s_waitcnt lgkmcnt(6)
    ds_read_b128 v[108:111], v61 offset:224
    ds_read_b128 v[124:127], v61 offset:480
    v_pk_fma_f32 v[16:17], v[64:65], v[8:9], v[16:17] op_sel_hi:[1,0,1]
    v_pk_fma_f32 v[18:19], v[66:67], v[8:9], v[18:19] op_sel_hi:[1,0,1]
    v_pk_fma_f32 v[20:21], v[68:69], v[8:9], v[20:21] op_sel_hi:[1,0,1]
    v_pk_fma_f32 v[22:23], v[70:71], v[8:9], v[22:23] op_sel_hi:[1,0,1]
    v_pk_fma_f32 v[24:25], v[72:73], v[8:9], v[24:25] op_sel_hi:[1,0,1]
    v_pk_fma_f32 v[26:27], v[74:75], v[8:9], v[26:27] op_sel_hi:[1,0,1]
    v_pk_fma_f32 v[28:29], v[76:77], v[8:9], v[28:29] op_sel_hi:[1,0,1]
    v_pk_fma_f32 v[30:31], v[78:79], v[8:9], v[30:31] op_sel_hi:[1,0,1]
    v_pk_fma_f32 v[16:17], v[80:81], v[8:9], v[16:17] op_sel_hi:[1,0,1]
    v_pk_fma_f32 v[18:19], v[82:83], v[8:9], v[18:19] op_sel_hi:[1,0,1]
    v_pk_fma_f32 v[20:21], v[84:85], v[8:9], v[20:21] op_sel_hi:[1,0,1]
    v_pk_fma_f32 v[22:23], v[86:87], v[8:9], v[22:23] op_sel_hi:[1,0,1]
    v_pk_fma_f32 v[24:25], v[88:89], v[8:9], v[24:25] op_sel_hi:[1,0,1]
    v_pk_fma_f32 v[26:27], v[90:91], v[8:9], v[26:27] op_sel_hi:[1,0,1]
    v_pk_fma_f32 v[28:29], v[92:93], v[8:9], v[28:29] op_sel_hi:[1,0,1]
    v_pk_fma_f32 v[30:31], v[94:95], v[8:9], v[30:31] op_sel_hi:[1,0,1]
    v_cvt_pk_bf16_f32 v80, v16, v17
    v_cvt_pk_bf16_f32 v81, v18, v19
    v_cvt_pk_bf16_f32 v82, v20, v21
    v_cvt_pk_bf16_f32 v83, v22, v23
    v_cvt_pk_bf16_f32 v84, v24, v25
    v_cvt_pk_bf16_f32 v85, v26, v27
    v_cvt_pk_bf16_f32 v86, v28, v29
    v_cvt_pk_bf16_f32 v87, v30, v31
    v_mul_f32 v56, 0x3fb8aa3b, v10
    v_add_u32 v244, 98304, v244
    v_add_u32 v245, 98304, v245
    v_add_u32 v246, 98304, v246
    v_add_u32 v247, 98304, v247
    v_mfma_f32_32x32x16_bf16 v[64:79], v[48:51], v[80:83], 0
    s_add_u32 s53, s53, 1
    v_mfma_f32_32x32x16_bf16 v[64:79], v[4:7], v[84:87], v[64:79]
    s_waitcnt lgkmcnt(0)
    v_add_f32 v96, v96, v112
    v_add_f32 v97, v97, v113
    v_add_f32 v98, v98, v114
    v_add_f32 v99, v99, v115
    v_add_f32 v100, v100, v116
    v_add_f32 v101, v101, v117
    v_add_f32 v102, v102, v118
    v_add_f32 v103, v103, v119
    v_pk_add_f32 v[104:105], v[104:105], v[120:121]
    v_pk_add_f32 v[106:107], v[106:107], v[122:123]
    v_pk_add_f32 v[108:109], v[108:109], v[124:125]
    v_pk_add_f32 v[110:111], v[110:111], v[126:127]
    v_pk_fma_f32 v[32:33], v[96:97], v[8:9], v[32:33] op_sel_hi:[1,0,1]
    v_pk_fma_f32 v[34:35], v[98:99], v[8:9], v[34:35] op_sel_hi:[1,0,1]
    v_pk_fma_f32 v[36:37], v[100:101], v[8:9], v[36:37] op_sel_hi:[1,0,1]
    v_pk_fma_f32 v[38:39], v[102:103], v[8:9], v[38:39] op_sel_hi:[1,0,1]
    v_pk_fma_f32 v[40:41], v[104:105], v[8:9], v[40:41] op_sel_hi:[1,0,1]
    v_pk_fma_f32 v[42:43], v[106:107], v[8:9], v[42:43] op_sel_hi:[1,0,1]
    v_pk_fma_f32 v[44:45], v[108:109], v[8:9], v[44:45] op_sel_hi:[1,0,1]
    v_pk_fma_f32 v[46:47], v[110:111], v[8:9], v[46:47] op_sel_hi:[1,0,1]
    v_pk_mul_f32 v[32:33], v[32:33], v[10:11] op_sel_hi:[1,0]
    v_pk_mul_f32 v[34:35], v[34:35], v[10:11] op_sel_hi:[1,0]
    v_pk_mul_f32 v[36:37], v[36:37], v[10:11] op_sel_hi:[1,0]
    v_pk_mul_f32 v[38:39], v[38:39], v[10:11] op_sel_hi:[1,0]
    v_pk_mul_f32 v[40:41], v[40:41], v[10:11] op_sel_hi:[1,0]
    v_pk_mul_f32 v[42:43], v[42:43], v[10:11] op_sel_hi:[1,0]
    v_pk_mul_f32 v[44:45], v[44:45], v[10:11] op_sel_hi:[1,0]
    v_pk_mul_f32 v[46:47], v[46:47], v[10:11] op_sel_hi:[1,0]
    v_cvt_pk_bf16_f32 v112, v32, v33
    v_cvt_pk_bf16_f32 v113, v34, v35
    v_cvt_pk_bf16_f32 v114, v36, v37
    v_cvt_pk_bf16_f32 v115, v38, v39
    v_cvt_pk_bf16_f32 v116, v40, v41
    v_cvt_pk_bf16_f32 v117, v42, v43
    v_cvt_pk_bf16_f32 v118, v44, v45
    v_cvt_pk_bf16_f32 v119, v46, v47
    ds_write_b128 v235, v[112:115]
    ds_write_b128 v235, v[116:119] offset:2048
    v_max3_f32 v32, v64, v65, v66
    v_max3_f32 v34, v72, v73, v74
    v_min3_f32 v36, v64, v65, v66
    v_min3_f32 v38, v72, v73, v74
    v_max3_f32 v32, v32, v67, v68
    v_max3_f32 v34, v34, v75, v76
    v_min3_f32 v36, v36, v67, v68
    v_min3_f32 v38, v38, v75, v76
    v_max3_f32 v32, v32, v69, v70
    v_max3_f32 v34, v34, v77, v78
    v_min3_f32 v36, v36, v69, v70
    v_min3_f32 v38, v38, v77, v78
    v_max_f32 v32, v32, v71
    v_max_f32 v34, v34, v79
    v_min_f32 v36, v36, v71
    v_min_f32 v38, v38, v79
    v_permlane32_swap_b32 v32, v34
    s_nop 0
    v_permlane32_swap_b32 v36, v38
    v_max_f32 v32, v32, v34
    v_min_f32 v36, v36, v38
    v_mov_b32 v34, v32
    v_mov_b32 v38, v36
    s_nop 0
    v_permlane32_swap_b32 v32, v34
    v_permlane32_swap_b32 v36, v38
    v_mul_f32 v32, v56, v32
    v_mul_f32 v34, v56, v34
    v_mul_f32 v36, v56, v36
    v_mul_f32 v38, v56, v38
    v_pk_fma_f32 v[16:17], v[64:65], v[56:57], v[36:37] op_sel_hi:[1,0,0] neg_lo:[0,1,0] neg_hi:[0,1,0]
    v_pk_fma_f32 v[18:19], v[66:67], v[56:57], v[36:37] op_sel_hi:[1,0,0] neg_lo:[0,1,0] neg_hi:[0,1,0]
    v_pk_fma_f32 v[20:21], v[68:69], v[56:57], v[36:37] op_sel_hi:[1,0,0] neg_lo:[0,1,0] neg_hi:[0,1,0]
    v_pk_fma_f32 v[22:23], v[70:71], v[56:57], v[36:37] op_sel_hi:[1,0,0] neg_lo:[0,1,0] neg_hi:[0,1,0]
    v_pk_fma_f32 v[64:65], v[64:65], v[56:57], v[32:33] op_sel_hi:[1,0,0] neg_lo:[0,0,1] neg_hi:[0,0,1]
    v_pk_fma_f32 v[66:67], v[66:67], v[56:57], v[32:33] op_sel_hi:[1,0,0] neg_lo:[0,0,1] neg_hi:[0,0,1]
    v_pk_fma_f32 v[68:69], v[68:69], v[56:57], v[32:33] op_sel_hi:[1,0,0] neg_lo:[0,0,1] neg_hi:[0,0,1]
    v_pk_fma_f32 v[70:71], v[70:71], v[56:57], v[32:33] op_sel_hi:[1,0,0] neg_lo:[0,0,1] neg_hi:[0,0,1]
    v_pk_fma_f32 v[24:25], v[72:73], v[56:57], v[38:39] op_sel_hi:[1,0,0] neg_lo:[0,1,0] neg_hi:[0,1,0]
    v_pk_fma_f32 v[26:27], v[74:75], v[56:57], v[38:39] op_sel_hi:[1,0,0] neg_lo:[0,1,0] neg_hi:[0,1,0]
    v_pk_fma_f32 v[28:29], v[76:77], v[56:57], v[38:39] op_sel_hi:[1,0,0] neg_lo:[0,1,0] neg_hi:[0,1,0]
    v_pk_fma_f32 v[30:31], v[78:79], v[56:57], v[38:39] op_sel_hi:[1,0,0] neg_lo:[0,1,0] neg_hi:[0,1,0]
    v_pk_fma_f32 v[72:73], v[72:73], v[56:57], v[34:35] op_sel_hi:[1,0,0] neg_lo:[0,0,1] neg_hi:[0,0,1]
    v_pk_fma_f32 v[74:75], v[74:75], v[56:57], v[34:35] op_sel_hi:[1,0,0] neg_lo:[0,0,1] neg_hi:[0,0,1]
    v_pk_fma_f32 v[76:77], v[76:77], v[56:57], v[34:35] op_sel_hi:[1,0,0] neg_lo:[0,0,1] neg_hi:[0,0,1]
    v_pk_fma_f32 v[78:79], v[78:79], v[56:57], v[34:35] op_sel_hi:[1,0,0] neg_lo:[0,0,1] neg_hi:[0,0,1]
    v_exp_f32 v64, v64
    v_exp_f32 v65, v65
    v_exp_f32 v66, v66
    v_exp_f32 v67, v67
    v_exp_f32 v68, v68
    v_exp_f32 v69, v69
    v_exp_f32 v70, v70
    v_exp_f32 v71, v71
    v_exp_f32 v72, v72
    v_exp_f32 v73, v73
    v_exp_f32 v74, v74
    v_exp_f32 v75, v75
    v_exp_f32 v76, v76
    v_exp_f32 v77, v77
    v_exp_f32 v78, v78
    v_exp_f32 v79, v79
    v_exp_f32 v16, v16
    v_exp_f32 v17, v17
    v_exp_f32 v18, v18
    v_exp_f32 v19, v19
    v_exp_f32 v20, v20
    v_exp_f32 v21, v21
    v_exp_f32 v22, v22
    v_exp_f32 v23, v23
    v_exp_f32 v24, v24
    v_exp_f32 v25, v25
    v_exp_f32 v26, v26
    v_exp_f32 v27, v27
    v_exp_f32 v28, v28
    v_exp_f32 v29, v29
    v_exp_f32 v30, v30
    v_exp_f32 v31, v31
    v_pk_add_f32 v[32:33], v[64:65], v[66:67]
    v_pk_add_f32 v[34:35], v[72:73], v[74:75]
    v_pk_add_f32 v[36:37], v[16:17], v[18:19]
    v_pk_add_f32 v[38:39], v[24:25], v[26:27]
    v_pk_add_f32 v[40:41], v[68:69], v[70:71]
    v_pk_add_f32 v[42:43], v[76:77], v[78:79]
    v_pk_add_f32 v[44:45], v[20:21], v[22:23]
    v_pk_add_f32 v[46:47], v[28:29], v[30:31]
    v_pk_add_f32 v[32:33], v[32:33], v[40:41]
    v_pk_add_f32 v[34:35], v[34:35], v[42:43]
    v_pk_add_f32 v[36:37], v[36:37], v[44:45]
    v_pk_add_f32 v[38:39], v[38:39], v[46:47]
    v_add_f32 v32, v32, v33
    v_add_f32 v34, v34, v35
    v_add_f32 v36, v36, v37
    v_add_f32 v38, v38, v39
    v_permlane32_swap_b32 v32, v34
    s_nop 0
    v_permlane32_swap_b32 v36, v38
    v_add_f32 v32, v32, v34
    v_add_f32 v36, v36, v38
    v_mov_b32 v34, v32
    v_mov_b32 v38, v36
    s_nop 0
    v_permlane32_swap_b32 v32, v34
    v_permlane32_swap_b32 v36, v38
    v_rcp_f32 v32, v32
    v_rcp_f32 v34, v34
    v_rcp_f32 v36, v36
    v_rcp_f32 v38, v38
    v_pk_mul_f32 v[64:65], v[64:65], v[32:33] op_sel_hi:[1,0]
    v_pk_mul_f32 v[66:67], v[66:67], v[32:33] op_sel_hi:[1,0]
    v_pk_mul_f32 v[68:69], v[68:69], v[32:33] op_sel_hi:[1,0]
    v_pk_mul_f32 v[70:71], v[70:71], v[32:33] op_sel_hi:[1,0]
    v_cvt_pk_bf16_f32 v96, v64, v65
    v_cvt_pk_bf16_f32 v97, v66, v67
    v_cvt_pk_bf16_f32 v98, v68, v69
    v_cvt_pk_bf16_f32 v99, v70, v71
    ds_write_b128 v233, v[96:99] offset:0
    v_pk_mul_f32 v[16:17], v[16:17], v[36:37] op_sel_hi:[1,0]
    v_pk_mul_f32 v[18:19], v[18:19], v[36:37] op_sel_hi:[1,0]
    v_pk_mul_f32 v[20:21], v[20:21], v[36:37] op_sel_hi:[1,0]
    v_pk_mul_f32 v[22:23], v[22:23], v[36:37] op_sel_hi:[1,0]
    v_cvt_pk_bf16_f32 v100, v16, v17
    v_cvt_pk_bf16_f32 v101, v18, v19
    v_cvt_pk_bf16_f32 v102, v20, v21
    v_cvt_pk_bf16_f32 v103, v22, v23
    ds_write_b128 v234, v[100:103] offset:0
    v_pk_mul_f32 v[72:73], v[72:73], v[34:35] op_sel_hi:[1,0]
    v_pk_mul_f32 v[74:75], v[74:75], v[34:35] op_sel_hi:[1,0]
    v_pk_mul_f32 v[76:77], v[76:77], v[34:35] op_sel_hi:[1,0]
    v_pk_mul_f32 v[78:79], v[78:79], v[34:35] op_sel_hi:[1,0]
    v_cvt_pk_bf16_f32 v104, v72, v73
    v_cvt_pk_bf16_f32 v105, v74, v75
    v_cvt_pk_bf16_f32 v106, v76, v77
    v_cvt_pk_bf16_f32 v107, v78, v79
    ds_write_b128 v233, v[104:107] offset:4096
    v_pk_mul_f32 v[24:25], v[24:25], v[38:39] op_sel_hi:[1,0]
    v_pk_mul_f32 v[26:27], v[26:27], v[38:39] op_sel_hi:[1,0]
    v_pk_mul_f32 v[28:29], v[28:29], v[38:39] op_sel_hi:[1,0]
    v_pk_mul_f32 v[30:31], v[30:31], v[38:39] op_sel_hi:[1,0]
    v_cvt_pk_bf16_f32 v108, v24, v25
    v_cvt_pk_bf16_f32 v109, v26, v27
    v_cvt_pk_bf16_f32 v110, v28, v29
    v_cvt_pk_bf16_f32 v111, v30, v31
    ds_write_b128 v234, v[108:111] offset:4096
    s_waitcnt vmcnt(6) lgkmcnt(0)
    s_barrier
    ds_read_b64_tr_b16 v[64:65], v236 offset:0
    ds_read_b64_tr_b16 v[66:67], v237 offset:0
    ds_read_b64_tr_b16 v[16:17], v238 offset:0
    ds_read_b64_tr_b16 v[18:19], v239 offset:0
    ds_read_b64_tr_b16 v[68:69], v236 offset:1024
    ds_read_b64_tr_b16 v[70:71], v237 offset:1024
    ds_read_b64_tr_b16 v[20:21], v238 offset:512
    ds_read_b64_tr_b16 v[22:23], v239 offset:512
    ds_read_b64_tr_b16 v[72:73], v236 offset:2048
    ds_read_b64_tr_b16 v[74:75], v237 offset:2048
    ds_read_b64_tr_b16 v[24:25], v238 offset:1024
    ds_read_b64_tr_b16 v[26:27], v239 offset:1024
    ds_read_b64_tr_b16 v[76:77], v236 offset:3072
    ds_read_b64_tr_b16 v[78:79], v237 offset:3072
    ds_read_b64_tr_b16 v[28:29], v238 offset:1536
    ds_read_b64_tr_b16 v[30:31], v239 offset:1536
    s_waitcnt lgkmcnt(12)
    v_mfma_f32_32x32x16_bf16 v[32:47], v[64:67], v[16:19], 0
    s_bfe_u32 s36, s53, 0x80000
    s_waitcnt lgkmcnt(8)
    v_mfma_f32_32x32x16_bf16 v[32:47], v[68:71], v[20:23], v[32:47]
    s_bfe_u32 s37, s53, 0x80008
    s_waitcnt lgkmcnt(4)
    v_mfma_f32_32x32x16_bf16 v[32:47], v[72:75], v[24:27], v[32:47]
    s_bfe_u32 s38, s53, 0x80010
    s_waitcnt lgkmcnt(0)
    v_mfma_f32_32x32x16_bf16 v[32:47], v[76:79], v[28:31], v[32:47]
    s_bfe_u32 s39, s53, 0x80018
    ds_read_b64_tr_b16 v[80:81], v244 offset:0
    ds_read_b64_tr_b16 v[82:83], v244 offset:512
    ds_read_b64_tr_b16 v[84:85], v245 offset:0
    ds_read_b64_tr_b16 v[86:87], v245 offset:512
    ds_read_b64_tr_b16 v[88:89], v246 offset:0
    ds_read_b64_tr_b16 v[90:91], v246 offset:512
    ds_read_b64_tr_b16 v[92:93], v247 offset:0
    ds_read_b64_tr_b16 v[94:95], v247 offset:512
    s_mov_b32 s63, 49152
    v_mov_b32_e64 v224, s53
    s_mov_b32 exec_lo, 0x0001ffff
    s_mov_b32 exec_hi, 0x0001ffff
    v_and_or_b32 v32, v32, v228, s36
    v_and_or_b32 v33, v33, v228, s37
    v_and_or_b32 v34, v34, v228, s38
    v_and_or_b32 v35, v35, v228, s39
    buffer_store_dwordx4 v[32:35], v231, s[16:19], 0 offen sc1
    v_and_or_b32 v36, v36, v228, s36
    v_and_or_b32 v37, v37, v228, s37
    v_and_or_b32 v38, v38, v228, s38
    v_and_or_b32 v39, v39, v228, s39
    buffer_store_dwordx4 v[36:39], v232, s[16:19], 0 offen sc1
    v_and_or_b32 v40, v40, v228, s36
    v_and_or_b32 v41, v41, v228, s37
    v_and_or_b32 v42, v42, v228, s38
    v_and_or_b32 v43, v43, v228, s39
    buffer_store_dwordx4 v[40:43], v231, s[16:19], s63 offen sc1
    v_and_or_b32 v44, v44, v228, s36
    v_and_or_b32 v45, v45, v228, s37
    v_and_or_b32 v46, v46, v228, s38
    v_and_or_b32 v47, v47, v228, s39
    buffer_store_dwordx4 v[44:47], v232, s[16:19], s63 offen sc1
    s_getreg_b32 s71, hwreg(HW_REG_XCC_ID, 0, 4)
    s_lshl4_add_u32 s71, s53, s71
    v_mov_b32 v14, s71
    s_mov_b64 exec, 1
    buffer_store_dword v14, v225, s[16:19], s95 offen sc1
    s_mov_b64 exec, -1
    s_mov_b64 exec, 0xffff
    buffer_load_dwordx4 v[52:55], v3, s[16:19], s74 offen
    s_mov_b64 exec, 1
    buffer_load_dword v52, v225, s[16:19], s96 offen
    s_mov_b64 exec, -1
    v_mov_b32 v58, 0
    s_waitcnt lgkmcnt(0)
    s_nop 0
    v_mfma_f32_32x32x16_bf16 v[16:31], v[80:83], v[128:131], 0
    ds_read_b64_tr_b16 v[96:97], v244 offset:8192
    ds_read_b64_tr_b16 v[98:99], v244 offset:8704
    v_mfma_f32_32x32x16_bf16 v[16:31], v[84:87], v[132:135], v[16:31]
    ds_read_b64_tr_b16 v[100:101], v245 offset:8192
    ds_read_b64_tr_b16 v[102:103], v245 offset:8704
    v_mfma_f32_32x32x16_bf16 v[16:31], v[88:91], a[0:3], v[16:31]
    ds_read_b64_tr_b16 v[104:105], v246 offset:8192
    ds_read_b64_tr_b16 v[106:107], v246 offset:8704
    v_mfma_f32_32x32x16_bf16 v[16:31], v[92:95], a[4:7], v[16:31]
    ds_read_b64_tr_b16 v[108:109], v247 offset:8192
    ds_read_b64_tr_b16 v[110:111], v247 offset:8704
    v_dot2c_f32_bf16 v58, s67, v80
    v_dot2c_f32_bf16 v58, s67, v81
    v_dot2c_f32_bf16 v58, s67, v82
    v_dot2c_f32_bf16 v58, s67, v83
    v_dot2c_f32_bf16 v58, s67, v88
    v_dot2c_f32_bf16 v58, s67, v89
    v_dot2c_f32_bf16 v58, s67, v90
    v_dot2c_f32_bf16 v58, s67, v91
    s_waitcnt lgkmcnt(0)
    s_nop 0
    v_mfma_f32_32x32x16_bf16 v[16:31], v[96:99], v[136:139], v[16:31]
    ds_read_b64_tr_b16 v[80:81], v244 offset:16384
    ds_read_b64_tr_b16 v[82:83], v244 offset:16896
    v_mfma_f32_32x32x16_bf16 v[16:31], v[100:103], v[140:143], v[16:31]
    ds_read_b64_tr_b16 v[84:85], v245 offset:16384
    ds_read_b64_tr_b16 v[86:87], v245 offset:16896
    v_mfma_f32_32x32x16_bf16 v[16:31], v[104:107], a[8:11], v[16:31]
    ds_read_b64_tr_b16 v[88:89], v246 offset:16384
    ds_read_b64_tr_b16 v[90:91], v246 offset:16896
    v_mfma_f32_32x32x16_bf16 v[16:31], v[108:111], a[12:15], v[16:31]
    ds_read_b64_tr_b16 v[92:93], v247 offset:16384
    ds_read_b64_tr_b16 v[94:95], v247 offset:16896
    v_dot2c_f32_bf16 v58, s67, v96
    v_dot2c_f32_bf16 v58, s67, v97
    v_dot2c_f32_bf16 v58, s67, v98
    v_dot2c_f32_bf16 v58, s67, v99
    v_dot2c_f32_bf16 v58, s67, v104
    v_dot2c_f32_bf16 v58, s67, v105
    v_dot2c_f32_bf16 v58, s67, v106
    v_dot2c_f32_bf16 v58, s67, v107
    s_waitcnt lgkmcnt(0)
    s_nop 0
    v_mfma_f32_32x32x16_bf16 v[16:31], v[80:83], v[144:147], v[16:31]
    ds_read_b64_tr_b16 v[96:97], v244 offset:24576
    ds_read_b64_tr_b16 v[98:99], v244 offset:25088
    v_mfma_f32_32x32x16_bf16 v[16:31], v[84:87], v[148:151], v[16:31]
    ds_read_b64_tr_b16 v[100:101], v245 offset:24576
    ds_read_b64_tr_b16 v[102:103], v245 offset:25088
    v_mfma_f32_32x32x16_bf16 v[16:31], v[88:91], a[16:19], v[16:31]
    ds_read_b64_tr_b16 v[104:105], v246 offset:24576
    ds_read_b64_tr_b16 v[106:107], v246 offset:25088
    v_mfma_f32_32x32x16_bf16 v[16:31], v[92:95], a[20:23], v[16:31]
    ds_read_b64_tr_b16 v[108:109], v247 offset:24576
    ds_read_b64_tr_b16 v[110:111], v247 offset:25088
    v_dot2c_f32_bf16 v58, s67, v80
    v_dot2c_f32_bf16 v58, s67, v81
    v_dot2c_f32_bf16 v58, s67, v82
    v_dot2c_f32_bf16 v58, s67, v83
    v_dot2c_f32_bf16 v58, s67, v88
    v_dot2c_f32_bf16 v58, s67, v89
    v_dot2c_f32_bf16 v58, s67, v90
    v_dot2c_f32_bf16 v58, s67, v91
    s_waitcnt lgkmcnt(0)
    s_nop 0
    v_mfma_f32_32x32x16_bf16 v[16:31], v[96:99], v[152:155], v[16:31]
    ds_read_b64_tr_b16 v[80:81], v244 offset:32768
    ds_read_b64_tr_b16 v[82:83], v244 offset:33280
    v_mfma_f32_32x32x16_bf16 v[16:31], v[100:103], v[156:159], v[16:31]
    ds_read_b64_tr_b16 v[84:85], v245 offset:32768
    ds_read_b64_tr_b16 v[86:87], v245 offset:33280
    v_mfma_f32_32x32x16_bf16 v[16:31], v[104:107], a[24:27], v[16:31]
    ds_read_b64_tr_b16 v[88:89], v246 offset:32768
    ds_read_b64_tr_b16 v[90:91], v246 offset:33280
    v_mfma_f32_32x32x16_bf16 v[16:31], v[108:111], a[28:31], v[16:31]
    ds_read_b64_tr_b16 v[92:93], v247 offset:32768
    ds_read_b64_tr_b16 v[94:95], v247 offset:33280
    v_dot2c_f32_bf16 v58, s67, v96
    v_dot2c_f32_bf16 v58, s67, v97
    v_dot2c_f32_bf16 v58, s67, v98
    v_dot2c_f32_bf16 v58, s67, v99
    v_dot2c_f32_bf16 v58, s67, v104
    v_dot2c_f32_bf16 v58, s67, v105
    v_dot2c_f32_bf16 v58, s67, v106
    v_dot2c_f32_bf16 v58, s67, v107
    s_waitcnt lgkmcnt(0)
    s_nop 0
    v_mfma_f32_32x32x16_bf16 v[16:31], v[80:83], v[160:163], v[16:31]
    ds_read_b64_tr_b16 v[96:97], v244 offset:40960
    ds_read_b64_tr_b16 v[98:99], v244 offset:41472
    v_mfma_f32_32x32x16_bf16 v[16:31], v[84:87], v[164:167], v[16:31]
    ds_read_b64_tr_b16 v[100:101], v245 offset:40960
    ds_read_b64_tr_b16 v[102:103], v245 offset:41472
    v_mfma_f32_32x32x16_bf16 v[16:31], v[88:91], a[32:35], v[16:31]
    ds_read_b64_tr_b16 v[104:105], v246 offset:40960
    ds_read_b64_tr_b16 v[106:107], v246 offset:41472
    v_mfma_f32_32x32x16_bf16 v[16:31], v[92:95], a[36:39], v[16:31]
    ds_read_b64_tr_b16 v[108:109], v247 offset:40960
    ds_read_b64_tr_b16 v[110:111], v247 offset:41472
    s_cmp_eq_u32 s51, 1
    s_cbranch_scc0 L_oiz_1
    buffer_load_dwordx4 v[128:131], v3, s[16:19], s52 offen offset:0 sc1
    buffer_load_dwordx4 v[132:135], v3, s[16:19], s52 offen offset:1024 sc1
    buffer_load_dwordx4 v[136:139], v3, s[16:19], s52 offen offset:2048 sc1
    buffer_load_dwordx4 v[140:143], v3, s[16:19], s52 offen offset:3072 sc1
    buffer_load_dwordx4 v[144:147], v3, s[16:19], s79 offen offset:0 sc1
    buffer_load_dwordx4 v[148:151], v3, s[16:19], s79 offen offset:1024 sc1
    buffer_load_dwordx4 v[152:155], v3, s[16:19], s79 offen offset:2048 sc1
    buffer_load_dwordx4 v[156:159], v3, s[16:19], s79 offen offset:3072 sc1
    s_branch L_oiend_2
L_oiz_1:
    s_cmp_eq_u32 s51, 2
    s_cbranch_scc0 L_oiend_2
    buffer_load_dwordx4 v[128:131], v3, s[16:19], s52 offen sc1
L_oiend_2:
    v_dot2c_f32_bf16 v58, s67, v80
    v_dot2c_f32_bf16 v58, s67, v81
    v_dot2c_f32_bf16 v58, s67, v82
    v_dot2c_f32_bf16 v58, s67, v83
    v_dot2c_f32_bf16 v58, s67, v88
    v_dot2c_f32_bf16 v58, s67, v89
    v_dot2c_f32_bf16 v58, s67, v90
    v_dot2c_f32_bf16 v58, s67, v91
    s_waitcnt lgkmcnt(0)
    v_mfma_f32_32x32x16_bf16 v[16:31], v[96:99], v[168:171], v[16:31]
    ds_read_b64_tr_b16 v[80:81], v244 offset:49152
    ds_read_b64_tr_b16 v[82:83], v244 offset:49664
    v_mfma_f32_32x32x16_bf16 v[16:31], v[100:103], v[172:175], v[16:31]
    ds_read_b64_tr_b16 v[84:85], v245 offset:49152
    ds_read_b64_tr_b16 v[86:87], v245 offset:49664
    v_mfma_f32_32x32x16_bf16 v[16:31], v[104:107], a[40:43], v[16:31]
    ds_read_b64_tr_b16 v[88:89], v246 offset:49152
    ds_read_b64_tr_b16 v[90:91], v246 offset:49664
    v_mfma_f32_32x32x16_bf16 v[16:31], v[108:111], a[44:47], v[16:31]
    ds_read_b64_tr_b16 v[92:93], v247 offset:49152
    ds_read_b64_tr_b16 v[94:95], v247 offset:49664
    v_dot2c_f32_bf16 v58, s67, v96
    v_dot2c_f32_bf16 v58, s67, v97
    v_dot2c_f32_bf16 v58, s67, v98
    v_dot2c_f32_bf16 v58, s67, v99
    v_dot2c_f32_bf16 v58, s67, v104
    v_dot2c_f32_bf16 v58, s67, v105
    v_dot2c_f32_bf16 v58, s67, v106
    v_dot2c_f32_bf16 v58, s67, v107
    s_waitcnt lgkmcnt(0)
    s_nop 0
    v_mfma_f32_32x32x16_bf16 v[16:31], v[80:83], v[176:179], v[16:31]
    ds_read_b64_tr_b16 v[96:97], v244 offset:57344
    ds_read_b64_tr_b16 v[98:99], v244 offset:57856
    v_mfma_f32_32x32x16_bf16 v[16:31], v[84:87], v[180:183], v[16:31]
    ds_read_b64_tr_b16 v[100:101], v245 offset:57344
    ds_read_b64_tr_b16 v[102:103], v245 offset:57856
    v_mfma_f32_32x32x16_bf16 v[16:31], v[88:91], a[48:51], v[16:31]
    ds_read_b64_tr_b16 v[104:105], v246 offset:57344
    ds_read_b64_tr_b16 v[106:107], v246 offset:57856
    v_mfma_f32_32x32x16_bf16 v[16:31], v[92:95], a[52:55], v[16:31]
    ds_read_b64_tr_b16 v[108:109], v247 offset:57344
    ds_read_b64_tr_b16 v[110:111], v247 offset:57856
    v_dot2c_f32_bf16 v58, s67, v80
    v_dot2c_f32_bf16 v58, s67, v81
    v_dot2c_f32_bf16 v58, s67, v82
    v_dot2c_f32_bf16 v58, s67, v83
    v_dot2c_f32_bf16 v58, s67, v88
    v_dot2c_f32_bf16 v58, s67, v89
    v_dot2c_f32_bf16 v58, s67, v90
    v_dot2c_f32_bf16 v58, s67, v91
    s_waitcnt lgkmcnt(0)
    v_mfma_f32_32x32x16_bf16 v[16:31], v[96:99], v[184:187], v[16:31]
    v_mfma_f32_32x32x16_bf16 v[16:31], v[100:103], v[188:191], v[16:31]
    v_mfma_f32_32x32x16_bf16 v[16:31], v[104:107], a[56:59], v[16:31]
    v_mfma_f32_32x32x16_bf16 v[16:31], v[108:111], a[60:63], v[16:31]
    v_dot2c_f32_bf16 v58, s67, v96
    v_dot2c_f32_bf16 v58, s67, v97
    v_dot2c_f32_bf16 v58, s67, v98
    v_dot2c_f32_bf16 v58, s67, v99
    v_dot2c_f32_bf16 v58, s67, v104
    v_dot2c_f32_bf16 v58, s67, v105
    v_dot2c_f32_bf16 v58, s67, v106
    v_dot2c_f32_bf16 v58, s67, v107
    s_nop 2
    v_mov_b32 v15, v58
    s_nop 1
    v_permlane32_swap_b32 v58, v15
    v_add_f32 v58, v58, v15
    ds_write_b32 v59, v58 offset:2048
    s_waitcnt lgkmcnt(0)
    s_barrier
    ds_read_b128 v[64:67], v61 offset:2048
    ds_read_b128 v[68:71], v61 offset:2080
    ds_read_b128 v[72:75], v61 offset:2112
    ds_read_b128 v[76:79], v61 offset:2144
    ds_read_b128 v[96:99], v61 offset:2304
    ds_read_b128 v[100:103], v61 offset:2336
    ds_read_b128 v[104:107], v61 offset:2368
    ds_read_b128 v[108:111], v61 offset:2400
    s_cmp_eq_u32 s51, 1
    s_cbranch_scc0 L_ownz_3
    s_mov_b32 s60, 0
L_own_5:
    s_waitcnt vmcnt(0)
    v_xor_b32_e64 v14, s36, v128
    v_bitop3_b32 v14, v14, v132, s36 bitop3:0xf6
    v_bitop3_b32 v14, v14, v136, s36 bitop3:0xf6
    v_bitop3_b32 v14, v14, v140, s36 bitop3:0xf6
    v_bitop3_b32 v14, v14, v144, s36 bitop3:0xf6
    v_bitop3_b32 v14, v14, v148, s36 bitop3:0xf6
    v_bitop3_b32 v14, v14, v152, s36 bitop3:0xf6
    v_bitop3_b32 v14, v14, v156, s36 bitop3:0xf6
    v_and_b32 v14, 0xff, v14
    v_cmp_ne_u32 vcc, 0, v14
    s_cbranch_vccz L_ownd_6
    buffer_load_dwordx4 v[128:131], v3, s[16:19], s52 offen offset:0 sc1
    buffer_load_dwordx4 v[132:135], v3, s[16:19], s52 offen offset:1024 sc1
    buffer_load_dwordx4 v[136:139], v3, s[16:19], s52 offen offset:2048 sc1
    buffer_load_dwordx4 v[140:143], v3, s[16:19], s52 offen offset:3072 sc1
    buffer_load_dwordx4 v[144:147], v3, s[16:19], s79 offen offset:0 sc1
    buffer_load_dwordx4 v[148:151], v3, s[16:19], s79 offen offset:1024 sc1
    buffer_load_dwordx4 v[152:155], v3, s[16:19], s79 offen offset:2048 sc1
    buffer_load_dwordx4 v[156:159], v3, s[16:19], s79 offen offset:3072 sc1
    s_add_u32 s60, s60, 1
    s_cmp_lt_u32 s60, 131072
    s_cbranch_scc1 L_own_5
    s_waitcnt vmcnt(0)
L_ownd_6:
    s_nop 0
    v_pk_add_f32 v[128:129], v[128:129], v[144:145]
    v_pk_add_f32 v[130:131], v[130:131], v[146:147]
    v_pk_add_f32 v[132:133], v[132:133], v[148:149]
    v_pk_add_f32 v[134:135], v[134:135], v[150:151]
    v_pk_add_f32 v[136:137], v[136:137], v[152:153]
    v_pk_add_f32 v[138:139], v[138:139], v[154:155]
    v_pk_add_f32 v[140:141], v[140:141], v[156:157]
    v_pk_add_f32 v[142:143], v[142:143], v[158:159]
    v_pk_add_f32 v[128:129], v[128:129], v[136:137]
    v_pk_add_f32 v[130:131], v[130:131], v[138:139]
    v_pk_add_f32 v[132:133], v[132:133], v[140:141]
    v_pk_add_f32 v[134:135], v[134:135], v[142:143]
    v_pk_add_f32 v[128:129], v[128:129], v[132:133]
    v_pk_add_f32 v[130:131], v[130:131], v[134:135]
    v_mov_b32 v132, v128
    v_mov_b32 v133, v129
    v_mov_b32 v134, v130
    v_mov_b32 v135, v131
    v_permlane32_swap_b32 v128, v132
    v_permlane32_swap_b32 v129, v133
    v_permlane32_swap_b32 v130, v134
    v_permlane32_swap_b32 v131, v135
    v_pk_add_f32 v[128:129], v[128:129], v[132:133]
    v_pk_add_f32 v[130:131], v[130:131], v[134:135]
    v_mov_b32 v132, v128
    v_mov_b32 v133, v129
    v_mov_b32 v134, v130
    v_mov_b32 v135, v131
    v_permlane16_swap_b32 v128, v132
    v_permlane16_swap_b32 v129, v133
    v_permlane16_swap_b32 v130, v134
    v_permlane16_swap_b32 v131, v135
    v_pk_add_f32 v[128:129], v[128:129], v[132:133]
    v_pk_add_f32 v[130:131], v[130:131], v[134:135]
    v_cvt_pk_bf16_f32 v136, v128, v129
    v_cvt_pk_bf16_f32 v137, v130, v131
    s_nop 0
    v_mov_b32_dpp v138, v136 row_shl:8 row_mask:0xf bank_mask:0xf
    v_mov_b32_dpp v139, v137 row_shl:8 row_mask:0xf bank_mask:0xf
    s_mov_b64 exec, 0xff
    buffer_store_dwordx4 v[136:139], v3, s[16:19], s73 offen sc1
    s_mov_b64 exec, -1
    s_branch L_ownend_4
L_ownz_3:
    s_cmp_eq_u32 s51, 2
    s_cbranch_scc0 L_ownend_4
    s_mov_b32 s60, 0
L_own_7:
    s_waitcnt vmcnt(0)
    v_xor_b32 v14, s36, v128
    v_bitop3_b32 v14, v14, v129, s37 bitop3:0xf6
    v_bitop3_b32 v14, v14, v130, s38 bitop3:0xf6
    v_bitop3_b32 v14, v14, v131, s39 bitop3:0xf6
    v_and_b32 v14, 0xff, v14
    v_cmp_ne_u32 vcc, 0, v14
    s_cbranch_vccz L_ownd_8
    buffer_load_dwordx4 v[128:131], v3, s[16:19], s52 offen sc1
    s_add_u32 s60, s60, 1
    s_cmp_lt_u32 s60, 131072
    s_cbranch_scc1 L_own_7
    s_waitcnt vmcnt(0)
L_ownd_8:
    s_nop 0
    v_add_f32_dpp v128, v128, v128 row_ror:8 row_mask:0xf bank_mask:0xf
    v_add_f32_dpp v129, v129, v129 row_ror:8 row_mask:0xf bank_mask:0xf
    v_add_f32_dpp v130, v130, v130 row_ror:8 row_mask:0xf bank_mask:0xf
    v_add_f32_dpp v131, v131, v131 row_ror:8 row_mask:0xf bank_mask:0xf
    v_add_f32_dpp v128, v128, v128 row_ror:4 row_mask:0xf bank_mask:0xf
    v_add_f32_dpp v129, v129, v129 row_ror:4 row_mask:0xf bank_mask:0xf
    v_add_f32_dpp v130, v130, v130 row_ror:4 row_mask:0xf bank_mask:0xf
    v_add_f32_dpp v131, v131, v131 row_ror:4 row_mask:0xf bank_mask:0xf
    v_add_f32_dpp v128, v128, v128 row_ror:2 row_mask:0xf bank_mask:0xf
    v_add_f32_dpp v129, v129, v129 row_ror:2 row_mask:0xf bank_mask:0xf
    v_add_f32_dpp v130, v130, v130 row_ror:2 row_mask:0xf bank_mask:0xf
    v_add_f32_dpp v131, v131, v131 row_ror:2 row_mask:0xf bank_mask:0xf
    v_mov_b32 v132, v128
    v_mov_b32 v133, v129
    v_mov_b32 v134, v130
    v_mov_b32 v135, v131
    v_permlane32_swap_b32 v128, v132
    v_permlane32_swap_b32 v129, v133
    v_permlane32_swap_b32 v130, v134
    v_permlane32_swap_b32 v131, v135
    v_pk_add_f32 v[128:129], v[128:129], v[132:133]
    v_pk_add_f32 v[130:131], v[130:131], v[134:135]
    v_mov_b32 v132, v128
    v_mov_b32 v133, v129
    v_mov_b32 v134, v130
    v_mov_b32 v135, v131
    v_permlane16_swap_b32 v128, v132
    v_permlane16_swap_b32 v129, v133
    v_permlane16_swap_b32 v130, v134
    v_permlane16_swap_b32 v131, v135
    v_pk_add_f32 v[128:129], v[128:129], v[132:133]
    v_pk_add_f32 v[130:131], v[130:131], v[134:135]
    v_cvt_pk_bf16_f32 v136, v128, v129
    v_cvt_pk_bf16_f32 v137, v130, v131
    s_nop 0
    v_mov_b32_dpp v138, v136 row_shl:1 row_mask:0xf bank_mask:0xf
    v_mov_b32_dpp v139, v137 row_shl:1 row_mask:0xf bank_mask:0xf
    s_mov_b64 exec, 1
    buffer_store_dwordx4 v[136:139], v3, s[16:19], s73 offen sc1
    s_mov_b64 exec, -1
L_ownend_4:
    s_mul_i32 s68, s48, 12288
    s_sub_u32 s61, s68, s77
    s_sub_u32 s63, s78, s77
    v_add_u32 v120, s61, v200
    v_add_u32 v122, s63, v200
    v_add_u32 v121, s61, v201
    v_add_u32 v123, s63, v201
    v_mov_b32 v228, -16
    s_and_b32 s36, s53, 15
    s_bfe_u32 s37, s53, 0x40004
    s_waitcnt lgkmcnt(0)
    v_pk_fma_f32 v[16:17], v[64:65], v[8:9], v[16:17] op_sel_hi:[1,0,1]
    v_pk_fma_f32 v[18:19], v[66:67], v[8:9], v[18:19] op_sel_hi:[1,0,1]
    v_pk_fma_f32 v[20:21], v[68:69], v[8:9], v[20:21] op_sel_hi:[1,0,1]
    v_pk_fma_f32 v[22:23], v[70:71], v[8:9], v[22:23] op_sel_hi:[1,0,1]
    v_pk_fma_f32 v[24:25], v[72:73], v[8:9], v[24:25] op_sel_hi:[1,0,1]
    v_pk_fma_f32 v[26:27], v[74:75], v[8:9], v[26:27] op_sel_hi:[1,0,1]
    v_pk_fma_f32 v[28:29], v[76:77], v[8:9], v[28:29] op_sel_hi:[1,0,1]
    v_pk_fma_f32 v[30:31], v[78:79], v[8:9], v[30:31] op_sel_hi:[1,0,1]
    v_pk_fma_f32 v[16:17], v[96:97], v[8:9], v[16:17] op_sel_hi:[1,0,1]
    v_pk_fma_f32 v[18:19], v[98:99], v[8:9], v[18:19] op_sel_hi:[1,0,1]
    v_pk_fma_f32 v[20:21], v[100:101], v[8:9], v[20:21] op_sel_hi:[1,0,1]
    v_pk_fma_f32 v[22:23], v[102:103], v[8:9], v[22:23] op_sel_hi:[1,0,1]
    v_pk_fma_f32 v[24:25], v[104:105], v[8:9], v[24:25] op_sel_hi:[1,0,1]
    v_pk_fma_f32 v[26:27], v[106:107], v[8:9], v[26:27] op_sel_hi:[1,0,1]
    v_pk_fma_f32 v[28:29], v[108:109], v[8:9], v[28:29] op_sel_hi:[1,0,1]
    v_pk_fma_f32 v[30:31], v[110:111], v[8:9], v[30:31] op_sel_hi:[1,0,1]
    v_cvt_pk_bf16_f32 v80, v16, v17
    v_cvt_pk_bf16_f32 v81, v18, v19
    v_cvt_pk_bf16_f32 v82, v20, v21
    v_cvt_pk_bf16_f32 v83, v22, v23
    v_cvt_pk_bf16_f32 v84, v24, v25
    v_cvt_pk_bf16_f32 v85, v26, v27
    v_cvt_pk_bf16_f32 v86, v28, v29
    v_cvt_pk_bf16_f32 v87, v30, v31
    v_mfma_f32_32x32x16_bf16 v[64:79], v[48:51], v[80:83], 0
    s_add_u32 m0, s77, 0
    s_add_u32 s66, s0, 0
    buffer_load_dwordx4 v192, s[20:23], s66 offen lds
    v_mfma_f32_32x32x16_bf16 v[64:79], v[4:7], v[84:87], v[64:79]
    buffer_load_dwordx4 v193, s[20:23], s66 offen offset:1024 lds
    s_add_u32 m0, s77, 2048
    s_add_u32 s66, s0, 16384
    buffer_load_dwordx4 v192, s[20:23], s66 offen lds
    s_nop 7
    s_nop 0
    v_max3_f32 v32, v64, v65, v66
    v_max3_f32 v34, v72, v73, v74
    v_min3_f32 v36, v64, v65, v66
    v_min3_f32 v38, v72, v73, v74
    v_max3_f32 v32, v32, v67, v68
    buffer_load_dwordx4 v193, s[20:23], s66 offen offset:1024 lds
    v_max3_f32 v34, v34, v75, v76
    v_min3_f32 v36, v36, v67, v68
    v_min3_f32 v38, v38, v75, v76
    v_max3_f32 v32, v32, v69, v70
    v_max3_f32 v34, v34, v77, v78
    s_add_u32 m0, s77, 4096
    s_add_u32 s66, s0, 32768
    buffer_load_dwordx4 v192, s[20:23], s66 offen lds
    v_min3_f32 v36, v36, v69, v70
    v_min3_f32 v38, v38, v77, v78
    v_max_f32 v32, v32, v71
    v_max_f32 v34, v34, v79
    v_min_f32 v36, v36, v71
    buffer_load_dwordx4 v193, s[20:23], s66 offen offset:1024 lds
    v_min_f32 v38, v38, v79
    v_permlane32_swap_b32 v32, v34
    s_nop 0
    v_permlane32_swap_b32 v36, v38
    v_max_f32 v32, v32, v34
    v_min_f32 v36, v36, v38
    s_add_u32 m0, s77, 6144
    s_add_u32 s66, s0, 49152
    buffer_load_dwordx4 v192, s[20:23], s66 offen lds
    v_mov_b32 v34, v32
    v_mov_b32 v38, v36
    s_nop 0
    v_permlane32_swap_b32 v32, v34
    v_permlane32_swap_b32 v36, v38
    v_mul_f32 v32, v56, v32
    buffer_load_dwordx4 v193, s[20:23], s66 offen offset:1024 lds
    v_mul_f32 v34, v56, v34
    v_mul_f32 v36, v56, v36
    v_mul_f32 v38, v56, v38
    v_pk_fma_f32 v[16:17], v[64:65], v[56:57], v[36:37] op_sel_hi:[1,0,0] neg_lo:[0,1,0] neg_hi:[0,1,0]
    v_pk_fma_f32 v[18:19], v[66:67], v[56:57], v[36:37] op_sel_hi:[1,0,0] neg_lo:[0,1,0] neg_hi:[0,1,0]
    s_add_u32 m0, s77, 8192
    s_add_u32 s66, s0, 65536
    buffer_load_dwordx4 v192, s[20:23], s66 offen lds
    v_pk_fma_f32 v[20:21], v[68:69], v[56:57], v[36:37] op_sel_hi:[1,0,0] neg_lo:[0,1,0] neg_hi:[0,1,0]
    v_pk_fma_f32 v[22:23], v[70:71], v[56:57], v[36:37] op_sel_hi:[1,0,0] neg_lo:[0,1,0] neg_hi:[0,1,0]
    v_pk_fma_f32 v[64:65], v[64:65], v[56:57], v[32:33] op_sel_hi:[1,0,0] neg_lo:[0,0,1] neg_hi:[0,0,1]
    v_pk_fma_f32 v[66:67], v[66:67], v[56:57], v[32:33] op_sel_hi:[1,0,0] neg_lo:[0,0,1] neg_hi:[0,0,1]
    v_pk_fma_f32 v[68:69], v[68:69], v[56:57], v[32:33] op_sel_hi:[1,0,0] neg_lo:[0,0,1] neg_hi:[0,0,1]
    buffer_load_dwordx4 v193, s[20:23], s66 offen offset:1024 lds
    v_pk_fma_f32 v[70:71], v[70:71], v[56:57], v[32:33] op_sel_hi:[1,0,0] neg_lo:[0,0,1] neg_hi:[0,0,1]
    v_pk_fma_f32 v[24:25], v[72:73], v[56:57], v[38:39] op_sel_hi:[1,0,0] neg_lo:[0,1,0] neg_hi:[0,1,0]
    v_pk_fma_f32 v[26:27], v[74:75], v[56:57], v[38:39] op_sel_hi:[1,0,0] neg_lo:[0,1,0] neg_hi:[0,1,0]
    v_pk_fma_f32 v[28:29], v[76:77], v[56:57], v[38:39] op_sel_hi:[1,0,0] neg_lo:[0,1,0] neg_hi:[0,1,0]
    v_pk_fma_f32 v[30:31], v[78:79], v[56:57], v[38:39] op_sel_hi:[1,0,0] neg_lo:[0,1,0] neg_hi:[0,1,0]
    s_add_u32 m0, s77, 10240
    s_add_u32 s66, s0, 81920
    buffer_load_dwordx4 v192, s[20:23], s66 offen lds
    v_pk_fma_f32 v[72:73], v[72:73], v[56:57], v[34:35] op_sel_hi:[1,0,0] neg_lo:[0,0,1] neg_hi:[0,0,1]
    v_pk_fma_f32 v[74:75], v[74:75], v[56:57], v[34:35] op_sel_hi:[1,0,0] neg_lo:[0,0,1] neg_hi:[0,0,1]
    v_pk_fma_f32 v[76:77], v[76:77], v[56:57], v[34:35] op_sel_hi:[1,0,0] neg_lo:[0,0,1] neg_hi:[0,0,1]
    v_pk_fma_f32 v[78:79], v[78:79], v[56:57], v[34:35] op_sel_hi:[1,0,0] neg_lo:[0,0,1] neg_hi:[0,0,1]
    v_exp_f32 v64, v64
    buffer_load_dwordx4 v193, s[20:23], s66 offen offset:1024 lds
    v_exp_f32 v65, v65
    v_exp_f32 v66, v66
    v_exp_f32 v67, v67
    v_exp_f32 v68, v68
    v_exp_f32 v69, v69
    s_add_u32 m0, s77, 12288
    s_add_u32 s66, s0, 98304
    buffer_load_dwordx4 v192, s[20:23], s66 offen lds
    v_exp_f32 v70, v70
    v_exp_f32 v71, v71
    v_exp_f32 v72, v72
    v_exp_f32 v73, v73
    v_exp_f32 v74, v74
    buffer_load_dwordx4 v193, s[20:23], s66 offen offset:1024 lds
    v_exp_f32 v75, v75
    v_exp_f32 v76, v76
    v_exp_f32 v77, v77
    v_exp_f32 v78, v78
    v_exp_f32 v79, v79
    s_add_u32 m0, s77, 14336
    s_add_u32 s66, s0, 114688
    buffer_load_dwordx4 v192, s[20:23], s66 offen lds
    v_exp_f32 v16, v16
    v_exp_f32 v17, v17
    v_exp_f32 v18, v18
    v_exp_f32 v19, v19
    v_exp_f32 v20, v20
    buffer_load_dwordx4 v193, s[20:23], s66 offen offset:1024 lds
    v_exp_f32 v21, v21
    v_exp_f32 v22, v22
    v_exp_f32 v23, v23
    v_exp_f32 v24, v24
    v_exp_f32 v25, v25
    s_add_u32 m0, s68, 0
    s_add_u32 s66, s1, 0
    buffer_load_dwordx4 v194, s[24:27], s66 offen lds
    v_exp_f32 v26, v26
    v_exp_f32 v27, v27
    v_exp_f32 v28, v28
    v_exp_f32 v29, v29
    v_exp_f32 v30, v30
    buffer_load_dwordx4 v195, s[24:27], s66 offen offset:1024 lds
    v_exp_f32 v31, v31
    v_pk_add_f32 v[32:33], v[64:65], v[66:67]
    v_pk_add_f32 v[34:35], v[72:73], v[74:75]
    v_pk_add_f32 v[36:37], v[16:17], v[18:19]
    v_pk_add_f32 v[38:39], v[24:25], v[26:27]
    s_add_u32 m0, s68, 2048
    s_add_u32 s66, s1, 57344
    buffer_load_dwordx4 v194, s[24:27], s66 offen lds
    v_pk_add_f32 v[40:41], v[68:69], v[70:71]
    v_pk_add_f32 v[42:43], v[76:77], v[78:79]
    v_pk_add_f32 v[44:45], v[20:21], v[22:23]
    v_pk_add_f32 v[46:47], v[28:29], v[30:31]
    v_pk_add_f32 v[32:33], v[32:33], v[40:41]
    buffer_load_dwordx4 v195, s[24:27], s66 offen offset:1024 lds
    v_pk_add_f32 v[34:35], v[34:35], v[42:43]
    v_pk_add_f32 v[36:37], v[36:37], v[44:45]
    v_pk_add_f32 v[38:39], v[38:39], v[46:47]
    v_add_f32 v32, v32, v33
    v_add_f32 v34, v34, v35
    s_add_u32 m0, s68, 4096
    s_add_u32 s66, s1, 114688
    buffer_load_dwordx4 v194, s[24:27], s66 offen lds
    v_add_f32 v36, v36, v37
    v_add_f32 v38, v38, v39
    v_permlane32_swap_b32 v32, v34
    s_nop 0
    v_permlane32_swap_b32 v36, v38
    v_add_f32 v32, v32, v34
    buffer_load_dwordx4 v195, s[24:27], s66 offen offset:1024 lds
    v_add_f32 v36, v36, v38
    v_mov_b32 v34, v32
    v_mov_b32 v38, v36
    s_nop 0
    v_permlane32_swap_b32 v32, v34
    v_permlane32_swap_b32 v36, v38
    s_add_u32 m0, s68, 6144
    s_add_u32 s66, s1, 172032
    buffer_load_dwordx4 v194, s[24:27], s66 offen lds
    v_rcp_f32 v32, v32
    v_rcp_f32 v34, v34
    v_rcp_f32 v36, v36
    v_rcp_f32 v38, v38
    v_pk_mul_f32 v[64:65], v[64:65], v[32:33] op_sel_hi:[1,0]
    buffer_load_dwordx4 v195, s[24:27], s66 offen offset:1024 lds
    v_pk_mul_f32 v[66:67], v[66:67], v[32:33] op_sel_hi:[1,0]
    v_pk_mul_f32 v[68:69], v[68:69], v[32:33] op_sel_hi:[1,0]
    v_pk_mul_f32 v[70:71], v[70:71], v[32:33] op_sel_hi:[1,0]
    v_cvt_pk_bf16_f32 v96, v64, v65
    v_cvt_pk_bf16_f32 v97, v66, v67
    s_add_u32 m0, s68, 8192
    s_add_u32 s66, s1, 229376
    buffer_load_dwordx4 v194, s[24:27], s66 offen lds
    v_cvt_pk_bf16_f32 v98, v68, v69
    v_cvt_pk_bf16_f32 v99, v70, v71
    v_pk_mul_f32 v[16:17], v[16:17], v[36:37] op_sel_hi:[1,0]
    v_pk_mul_f32 v[18:19], v[18:19], v[36:37] op_sel_hi:[1,0]
    v_pk_mul_f32 v[20:21], v[20:21], v[36:37] op_sel_hi:[1,0]
    buffer_load_dwordx4 v195, s[24:27], s66 offen offset:1024 lds
    v_pk_mul_f32 v[22:23], v[22:23], v[36:37] op_sel_hi:[1,0]
    v_cvt_pk_bf16_f32 v100, v16, v17
    v_cvt_pk_bf16_f32 v101, v18, v19
    v_cvt_pk_bf16_f32 v102, v20, v21
    v_cvt_pk_bf16_f32 v103, v22, v23
    s_add_u32 m0, s68, 10240
    s_add_u32 s66, s1, 286720
    buffer_load_dwordx4 v194, s[24:27], s66 offen lds
    v_pk_mul_f32 v[72:73], v[72:73], v[34:35] op_sel_hi:[1,0]
    v_pk_mul_f32 v[74:75], v[74:75], v[34:35] op_sel_hi:[1,0]
    v_pk_mul_f32 v[76:77], v[76:77], v[34:35] op_sel_hi:[1,0]
    v_pk_mul_f32 v[78:79], v[78:79], v[34:35] op_sel_hi:[1,0]
    v_cvt_pk_bf16_f32 v104, v72, v73
    buffer_load_dwordx4 v195, s[24:27], s66 offen offset:1024 lds
    v_cvt_pk_bf16_f32 v105, v74, v75
    v_cvt_pk_bf16_f32 v106, v76, v77
    v_cvt_pk_bf16_f32 v107, v78, v79
    v_pk_mul_f32 v[24:25], v[24:25], v[38:39] op_sel_hi:[1,0]
    v_pk_mul_f32 v[26:27], v[26:27], v[38:39] op_sel_hi:[1,0]
    v_pk_mul_f32 v[28:29], v[28:29], v[38:39] op_sel_hi:[1,0]
    v_pk_mul_f32 v[30:31], v[30:31], v[38:39] op_sel_hi:[1,0]
    v_cvt_pk_bf16_f32 v108, v24, v25
    v_cvt_pk_bf16_f32 v109, v26, v27
    v_cvt_pk_bf16_f32 v110, v28, v29
    v_cvt_pk_bf16_f32 v111, v30, v31
    s_barrier
    buffer_load_dword v13, v230, s[16:19], 0 offen sc1
    s_mov_b32 s60, 0
L_fin_9:
    buffer_load_dwordx4 v[64:67], v229, s[16:19], 0 offen offset:0 sc1
    buffer_load_dwordx4 v[68:71], v229, s[16:19], 0 offen offset:1024 sc1
    buffer_load_dwordx4 v[72:75], v229, s[16:19], 0 offen offset:2048 sc1
    buffer_load_dwordx4 v[76:79], v229, s[16:19], 0 offen offset:3072 sc1
    s_waitcnt vmcnt(0)
    v_max3_u32 v14, v64, v68, v72
    v_max_u32 v14, v14, v76
    v_cmp_eq_u32 vcc, -1, v14
    s_cbranch_vccz L_find_10
    s_add_u32 s60, s60, 1
    s_cmp_lt_u32 s60, 131072
    s_cbranch_scc1 L_fin_9
L_find_10:
    v_mfma_f32_32x32x16_bf16 v[16:31], v[64:67], v[96:99], 0
    v_cmp_ne_u32 vcc, s71, v13
    v_mfma_f32_32x32x16_bf16 v[16:31], v[68:71], v[100:103], v[16:31]
    s_cmp_eq_u64 vcc, 0
    s_cselect_b32 s71, 1, 0
    s_nop 0
    v_mfma_f32_32x32x16_bf16 v[32:47], v[72:75], v[104:107], 0
    ds_read_b64_tr_b16 a[192:193], v198 offset:0
    ds_read_b64_tr_b16 a[194:195], v198 offset:1024
    ds_read_b64_tr_b16 a[196:197], v199 offset:0
    ds_read_b64_tr_b16 a[198:199], v199 offset:1024
    v_mfma_f32_32x32x16_bf16 v[32:47], v[76:79], v[108:111], v[32:47]
    ds_read_b64_tr_b16 a[200:201], v198 offset:2048
    ds_read_b64_tr_b16 a[202:203], v198 offset:3072
    ds_read_b64_tr_b16 a[204:205], v199 offset:2048
    ds_read_b64_tr_b16 a[206:207], v199 offset:3072
    v_add_f32 v24, 0x358637bd, v24
    v_rcp_f32 v24, v24
    s_nop 0
    v_pk_mul_f32 v[16:17], v[16:17], v[24:25] op_sel_hi:[1,0]
    v_pk_mul_f32 v[18:19], v[18:19], v[24:25] op_sel_hi:[1,0]
    v_pk_mul_f32 v[20:21], v[20:21], v[24:25] op_sel_hi:[1,0]
    v_pk_mul_f32 v[22:23], v[22:23], v[24:25] op_sel_hi:[1,0]
    v_cvt_pk_bf16_f32 v28, v16, v17
    v_cvt_pk_bf16_f32 v29, v18, v19
    v_cvt_pk_bf16_f32 v30, v20, v21
    v_cvt_pk_bf16_f32 v31, v22, v23
    v_add_f32 v40, 0x358637bd, v40
    v_rcp_f32 v40, v40
    s_nop 0
    v_pk_mul_f32 v[32:33], v[32:33], v[40:41] op_sel_hi:[1,0]
    v_pk_mul_f32 v[34:35], v[34:35], v[40:41] op_sel_hi:[1,0]
    v_pk_mul_f32 v[36:37], v[36:37], v[40:41] op_sel_hi:[1,0]
    v_pk_mul_f32 v[38:39], v[38:39], v[40:41] op_sel_hi:[1,0]
    v_cvt_pk_bf16_f32 v44, v32, v33
    v_cvt_pk_bf16_f32 v45, v34, v35
    v_cvt_pk_bf16_f32 v46, v36, v37
    v_cvt_pk_bf16_f32 v47, v38, v39
    s_cmp_eq_u32 s71, 0
    s_cbranch_scc0 L_loc_11
    buffer_store_dwordx4 v[28:31], v3, s[16:19], s72 offen offset:0 sc1
    buffer_store_dwordx4 v[44:47], v3, s[16:19], s72 offen offset:2048 sc1
    s_waitcnt vmcnt(0)
    s_mov_b64 exec, 1
    buffer_store_dword v224, v225, s[16:19], s96 offen sc1
    s_mov_b64 exec, -1
    s_branch L_locj_12
L_loc_11:
    buffer_store_dwordx4 v[28:31], v3, s[16:19], s72 offen offset:0 sc1
    buffer_store_dwordx4 v[44:47], v3, s[16:19], s72 offen offset:2048 sc1
    s_waitcnt vmcnt(0)
    s_mov_b64 exec, 1
    buffer_store_dword v224, v225, s[16:19], s96 offen
    s_mov_b64 exec, -1
L_locj_12:
    s_lshl_b32 s63, s48, 11
    s_add_u32 s63, s63, 49152
    s_add_u32 m0, s63, 0
    s_add_u32 s61, s6, 0
    buffer_load_dwordx4 v213, s[8:11], s61 offen lds
    s_add_u32 m0, s63, 1024
    s_add_u32 s61, s6, 16384
    buffer_load_dwordx4 v213, s[8:11], s61 offen lds
    ds_read_b64_tr_b16 a[208:209], v198 offset:4096
    ds_read_b64_tr_b16 a[210:211], v198 offset:5120
    ds_read_b64_tr_b16 a[212:213], v199 offset:4096
    ds_read_b64_tr_b16 a[214:215], v199 offset:5120
    ds_read_b64_tr_b16 a[216:217], v198 offset:6144
    ds_read_b64_tr_b16 a[218:219], v198 offset:7168
    ds_read_b64_tr_b16 a[220:221], v199 offset:6144
    ds_read_b64_tr_b16 a[222:223], v199 offset:7168
    ds_read_b64_tr_b16 a[224:225], v198 offset:8192
    ds_read_b64_tr_b16 a[226:227], v198 offset:9216
    ds_read_b64_tr_b16 a[228:229], v199 offset:8192
    ds_read_b64_tr_b16 a[230:231], v199 offset:9216
    ds_read_b64_tr_b16 a[232:233], v198 offset:10240
    ds_read_b64_tr_b16 a[234:235], v198 offset:11264
    ds_read_b64_tr_b16 a[236:237], v199 offset:10240
    ds_read_b64_tr_b16 a[238:239], v199 offset:11264
    ds_read_b64_tr_b16 a[240:241], v198 offset:12288
    ds_read_b64_tr_b16 a[242:243], v198 offset:13312
    ds_read_b64_tr_b16 a[244:245], v199 offset:12288
    ds_read_b64_tr_b16 a[246:247], v199 offset:13312
    ds_read_b64_tr_b16 a[248:249], v198 offset:14336
    ds_read_b64_tr_b16 a[250:251], v198 offset:15360
    ds_read_b64_tr_b16 a[252:253], v199 offset:14336
    ds_read_b64_tr_b16 a[254:255], v199 offset:15360
    ds_read_b64_tr_b16 a[64:65], v120 offset:0
    ds_read_b64_tr_b16 a[66:67], v120 offset:512
    ds_read_b64_tr_b16 a[68:69], v121 offset:0
    ds_read_b64_tr_b16 a[70:71], v121 offset:512
    ds_read_b64_tr_b16 a[72:73], v120 offset:2048
    ds_read_b64_tr_b16 a[74:75], v120 offset:2560
    ds_read_b64_tr_b16 a[76:77], v121 offset:2048
    ds_read_b64_tr_b16 a[78:79], v121 offset:2560
    ds_read_b64_tr_b16 a[80:81], v120 offset:4096
    ds_read_b64_tr_b16 a[82:83], v120 offset:4608
    ds_read_b64_tr_b16 a[84:85], v121 offset:4096
    ds_read_b64_tr_b16 a[86:87], v121 offset:4608
    ds_read_b64_tr_b16 a[88:89], v120 offset:6144
    ds_read_b64_tr_b16 a[90:91], v120 offset:6656
    ds_read_b64_tr_b16 a[92:93], v121 offset:6144
    ds_read_b64_tr_b16 a[94:95], v121 offset:6656
    ds_read_b64_tr_b16 a[96:97], v120 offset:8192
    ds_read_b64_tr_b16 a[98:99], v120 offset:8704
    ds_read_b64_tr_b16 a[100:101], v121 offset:8192
    ds_read_b64_tr_b16 a[102:103], v121 offset:8704
    ds_read_b64_tr_b16 a[104:105], v120 offset:10240
    ds_read_b64_tr_b16 a[106:107], v120 offset:10752
    ds_read_b64_tr_b16 a[108:109], v121 offset:10240
    ds_read_b64_tr_b16 a[110:111], v121 offset:10752
    s_add_u32 m0, s78, 0
    s_add_u32 s66, s1, 344064
    buffer_load_dwordx4 v194, s[24:27], s66 offen lds
    buffer_load_dwordx4 v195, s[24:27], s66 offen offset:1024 lds
    s_add_u32 m0, s78, 2048
    s_add_u32 s66, s1, 401408
    buffer_load_dwordx4 v194, s[24:27], s66 offen lds
    buffer_load_dwordx4 v195, s[24:27], s66 offen offset:1024 lds
    s_and_b32 s61, s49, 1
    s_lshl_b32 s64, s49, 16
    s_lshl_b32 s62, s48, 14
    s_add_u32 s64, s64, s62
    s_lshl_b32 s62, s61, 13
    s_add_u32 s64, s64, s62
    s_add_u32 s64, s64, 4194304
    s_xor_b32 s65, s64, 8192
    s_mov_b64 exec, 0xff
    s_mov_b32 s60, 0
L_p2_h_13:
    buffer_load_dwordx4 v[88:91], v206, s[16:19], 0 offen sc1
    s_waitcnt vmcnt(0)
    v_xor_b32 v12, s53, v88
    v_bitop3_b32 v12, v12, v89, s53 bitop3:0xf6
    v_bitop3_b32 v12, v12, v90, s53 bitop3:0xf6
    v_bitop3_b32 v12, v12, v91, s53 bitop3:0xf6
    v_cmp_ne_u32 vcc, 0, v12
    s_cbranch_vccz L_p2_hd_14
    s_add_u32 s60, s60, 1
    s_cmp_lt_u32 s60, 131072
    s_cbranch_scc1 L_p2_h_13
L_p2_hd_14:
    s_mov_b64 exec, -1
    s_add_u32 s63, s64, 0
    buffer_load_dwordx4 v[128:131], v204, s[16:19], s63 offen offset:0 sc1
    buffer_load_dwordx4 v[132:135], v205, s[16:19], s63 offen offset:0 sc1
    buffer_load_dwordx4 v[136:139], v204, s[16:19], s63 offen offset:2048 sc1
    buffer_load_dwordx4 v[140:143], v205, s[16:19], s63 offen offset:2048 sc1
    s_add_u32 s63, s64, 4096
    buffer_load_dwordx4 v[144:147], v204, s[16:19], s63 offen offset:0 sc1
    buffer_load_dwordx4 v[148:151], v205, s[16:19], s63 offen offset:0 sc1
    buffer_load_dwordx4 v[152:155], v204, s[16:19], s63 offen offset:2048 sc1
    buffer_load_dwordx4 v[156:159], v205, s[16:19], s63 offen offset:2048 sc1
    ds_read_b64 v[96:97], v214
    v_xor_b32 v14, 16, v214
    ds_read_b64 v[98:99], v14
    v_xor_b32 v14, 32, v214
    ds_read_b64 v[100:101], v14
    v_xor_b32 v14, 48, v214
    ds_read_b64 v[102:103], v14
    s_lshl2_add_u32 s61, s2, s48
    s_cmp_eq_u32 s61, 3
    s_cbranch_scc0 L_noep_15
    s_mov_b64 exec, 1
    buffer_store_dword v224, v225, s[16:19], 0 offen sc1
    s_mov_b64 exec, -1
L_noep_15:
    s_waitcnt lgkmcnt(0)
    v_lshlrev_b32 v104, 16, v96
    v_and_b32 v105, 0xffff0000, v96
    v_lshlrev_b32 v106, 16, v97
    v_and_b32 v107, 0xffff0000, v97
    v_lshlrev_b32 v108, 16, v98
    v_and_b32 v109, 0xffff0000, v98
    v_lshlrev_b32 v110, 16, v99
    v_and_b32 v111, 0xffff0000, v99
    v_lshlrev_b32 v112, 16, v100
    v_and_b32 v113, 0xffff0000, v100
    v_lshlrev_b32 v114, 16, v101
    v_and_b32 v115, 0xffff0000, v101
    v_lshlrev_b32 v116, 16, v102
    v_and_b32 v117, 0xffff0000, v102
    v_lshlrev_b32_e64 v118, 16, v103
    v_and_b32 v119, 0xffff0000, v103
    ds_read_b64_tr_b16 a[112:113], v122 offset:0
    ds_read_b64_tr_b16 a[114:115], v122 offset:512
    ds_read_b64_tr_b16 a[116:117], v123 offset:0
    ds_read_b64_tr_b16 a[118:119], v123 offset:512
    ds_read_b64_tr_b16 a[120:121], v122 offset:2048
    ds_read_b64_tr_b16 a[122:123], v122 offset:2560
    ds_read_b64_tr_b16 a[124:125], v123 offset:2048
    ds_read_b64_tr_b16 a[126:127], v123 offset:2560
    s_waitcnt vmcnt(6)
    v_mfma_f32_32x32x16_bf16 v[16:31], a[192:195], v[128:131], 0
    s_add_u32 s63, s65, 0
    buffer_load_dwordx4 v[160:163], v204, s[16:19], s63 offen offset:0 sc1
    v_mfma_f32_32x32x16_bf16 v[48:63], a[196:199], v[128:131], 0
    buffer_load_dwordx4 v[164:167], v205, s[16:19], s63 offen offset:0 sc1
    v_mfma_f32_32x32x16_bf16 v[32:47], a[192:195], v[132:135], 0
    buffer_load_dwordx4 v[168:171], v204, s[16:19], s63 offen offset:2048 sc1
    v_mfma_f32_32x32x16_bf16 v[64:79], a[196:199], v[132:135], 0
    buffer_load_dwordx4 v[172:175], v205, s[16:19], s63 offen offset:2048 sc1
    s_waitcnt vmcnt(8)
    s_nop 0
    v_mfma_f32_32x32x16_bf16 v[16:31], a[200:203], v[136:139], v[16:31]
    s_add_u32 s63, s65, 4096
    buffer_load_dwordx4 v[176:179], v204, s[16:19], s63 offen offset:0 sc1
    v_mfma_f32_32x32x16_bf16 v[48:63], a[204:207], v[136:139], v[48:63]
    buffer_load_dwordx4 v[180:183], v205, s[16:19], s63 offen offset:0 sc1
    v_mfma_f32_32x32x16_bf16 v[32:47], a[200:203], v[140:143], v[32:47]
    buffer_load_dwordx4 v[184:187], v204, s[16:19], s63 offen offset:2048 sc1
    v_mfma_f32_32x32x16_bf16 v[64:79], a[204:207], v[140:143], v[64:79]
    buffer_load_dwordx4 v[188:191], v205, s[16:19], s63 offen offset:2048 sc1
    s_waitcnt vmcnt(10)
    s_barrier
    v_mfma_f32_32x32x16_bf16 v[16:31], a[208:211], v[144:147], v[16:31]
    s_add_u32 m0, s78, 4096
    s_add_u32 s66, s1, 458752
    buffer_load_dwordx4 v194, s[24:27], s66 offen lds
    v_mfma_f32_32x32x16_bf16 v[48:63], a[212:215], v[144:147], v[48:63]
    buffer_load_dwordx4 v195, s[24:27], s66 offen offset:1024 lds
    v_mfma_f32_32x32x16_bf16 v[32:47], a[208:211], v[148:151], v[32:47]
    v_mfma_f32_32x32x16_bf16 v[64:79], a[212:215], v[148:151], v[64:79]
    s_waitcnt vmcnt(10)
    s_nop 0
    v_mfma_f32_32x32x16_bf16 v[16:31], a[216:219], v[152:155], v[16:31]
    s_add_u32 m0, s78, 6144
    s_add_u32 s66, s1, 516096
    buffer_load_dwordx4 v194, s[24:27], s66 offen lds
    v_mfma_f32_32x32x16_bf16 v[48:63], a[220:223], v[152:155], v[48:63]
    buffer_load_dwordx4 v195, s[24:27], s66 offen offset:1024 lds
    v_mfma_f32_32x32x16_bf16 v[32:47], a[216:219], v[156:159], v[32:47]
    v_mfma_f32_32x32x16_bf16 v[64:79], a[220:223], v[156:159], v[64:79]
    s_waitcnt vmcnt(10)
    v_mfma_f32_32x32x16_bf16 v[16:31], a[224:227], v[160:163], v[16:31]
    s_add_u32 m0, s77, 0
    s_add_u32 s66, s1, 573440
    buffer_load_dwordx4 v194, s[24:27], s66 offen lds
    v_mfma_f32_32x32x16_bf16 v[48:63], a[228:231], v[160:163], v[48:63]
    buffer_load_dwordx4 v195, s[24:27], s66 offen offset:1024 lds
    v_mfma_f32_32x32x16_bf16 v[32:47], a[224:227], v[164:167], v[32:47]
    v_mfma_f32_32x32x16_bf16 v[64:79], a[228:231], v[164:167], v[64:79]
    s_waitcnt vmcnt(10)
    s_nop 0
    v_mfma_f32_32x32x16_bf16 v[16:31], a[232:235], v[168:171], v[16:31]
    s_add_u32 m0, s77, 2048
    s_add_u32 s66, s1, 630784
    buffer_load_dwordx4 v194, s[24:27], s66 offen lds
    v_mfma_f32_32x32x16_bf16 v[48:63], a[236:239], v[168:171], v[48:63]
    buffer_load_dwordx4 v195, s[24:27], s66 offen offset:1024 lds
    v_mfma_f32_32x32x16_bf16 v[32:47], a[232:235], v[172:175], v[32:47]
    v_mfma_f32_32x32x16_bf16 v[64:79], a[236:239], v[172:175], v[64:79]
    s_waitcnt vmcnt(10)
    s_nop 0
    v_mfma_f32_32x32x16_bf16 v[16:31], a[240:243], v[176:179], v[16:31]
    s_add_u32 s60, s98, 1146880
    buffer_load_dwordx4 v[124:127], v226, s[24:27], s60 offen
    v_mfma_f32_32x32x16_bf16 v[48:63], a[244:247], v[176:179], v[48:63]
    s_add_u32 s60, s98, 1376256
    buffer_load_dwordx4 v[124:127], v226, s[24:27], s60 offen
    v_mfma_f32_32x32x16_bf16 v[32:47], a[240:243], v[180:183], v[32:47]
    v_mfma_f32_32x32x16_bf16 v[64:79], a[244:247], v[180:183], v[64:79]
    s_waitcnt vmcnt(10)
    v_mfma_f32_32x32x16_bf16 v[16:31], a[248:251], v[184:187], v[16:31]
    s_add_u32 s60, s98, 1605632
    buffer_load_dwordx4 v[124:127], v226, s[24:27], s60 offen
    v_mfma_f32_32x32x16_bf16 v[48:63], a[252:255], v[184:187], v[48:63]
    v_mfma_f32_32x32x16_bf16 v[32:47], a[248:251], v[188:191], v[32:47]
    v_mfma_f32_32x32x16_bf16 v[64:79], a[252:255], v[188:191], v[64:79]
    s_nop 10
    ds_write_b128 v209, v[32:35] offset:0
    ds_write_b128 v209, v[36:39] offset:1024
    ds_write_b128 v209, v[40:43] offset:2048
    ds_write_b128 v209, v[44:47] offset:3072
    ds_write_b128 v210, v[48:51] offset:0
    ds_write_b128 v210, v[52:55] offset:1024
    ds_write_b128 v210, v[56:59] offset:2048
    ds_write_b128 v210, v[60:63] offset:3072
    ds_write_b128 v211, v[64:67] offset:0
    ds_write_b128 v211, v[68:71] offset:1024
    ds_write_b128 v211, v[72:75] offset:2048
    ds_write_b128 v211, v[76:79] offset:3072
    s_waitcnt lgkmcnt(0)
    s_barrier
    ds_read_b128 v[32:35], v212 offset:0
    ds_read_b128 v[36:39], v212 offset:1024
    ds_read_b128 v[40:43], v212 offset:2048
    ds_read_b128 v[44:47], v212 offset:3072
    ds_read_b128 v[48:51], v212 offset:4096
    ds_read_b128 v[52:55], v212 offset:5120
    ds_read_b128 v[56:59], v212 offset:6144
    ds_read_b128 v[60:63], v212 offset:7168
    ds_read_b128 v[64:67], v212 offset:8192
    ds_read_b128 v[68:71], v212 offset:9216
    ds_read_b128 v[72:75], v212 offset:10240
    ds_read_b128 v[76:79], v212 offset:11264
    s_xor_b32 s61, s58, s59
    s_lshl_b32 s61, s61, 6
    v_xor_b32 v198, s61, v198
    v_xor_b32 v199, s61, v199
    v_xor_b32 v202, s61, v202
    v_xor_b32 v203, s61, v203
    v_pk_add_f32 v[16:17], v[16:17], v[104:105]
    v_pk_add_f32 v[18:19], v[18:19], v[106:107]
    v_pk_add_f32 v[20:21], v[20:21], v[108:109]
    v_pk_add_f32 v[22:23], v[22:23], v[110:111]
    v_pk_add_f32 v[24:25], v[24:25], v[112:113]
    v_pk_add_f32 v[26:27], v[26:27], v[114:115]
    v_pk_add_f32 v[28:29], v[28:29], v[116:117]
    v_pk_add_f32 v[30:31], v[30:31], v[118:119]
    v_mov_b32 v8, 0
    v_mov_b32 v9, 0
    s_waitcnt lgkmcnt(8)
    s_nop 0
    v_pk_add_f32 v[16:17], v[16:17], v[32:33]
    v_pk_add_f32 v[18:19], v[18:19], v[34:35]
    v_pk_add_f32 v[20:21], v[20:21], v[36:37]
    v_pk_add_f32 v[22:23], v[22:23], v[38:39]
    v_pk_add_f32 v[24:25], v[24:25], v[40:41]
    v_pk_add_f32 v[26:27], v[26:27], v[42:43]
    v_pk_add_f32 v[28:29], v[28:29], v[44:45]
    v_pk_add_f32 v[30:31], v[30:31], v[46:47]
    s_add_u32 m0, s77, 4096
    s_add_u32 s66, s1, 688128
    buffer_load_dwordx4 v194, s[24:27], s66 offen lds
    s_waitcnt lgkmcnt(4)
    s_nop 0
    v_pk_add_f32 v[16:17], v[16:17], v[48:49]
    v_pk_add_f32 v[18:19], v[18:19], v[50:51]
    v_pk_add_f32 v[20:21], v[20:21], v[52:53]
    v_pk_add_f32 v[22:23], v[22:23], v[54:55]
    v_pk_add_f32 v[24:25], v[24:25], v[56:57]
    v_pk_add_f32 v[26:27], v[26:27], v[58:59]
    v_pk_add_f32 v[28:29], v[28:29], v[60:61]
    v_pk_add_f32 v[30:31], v[30:31], v[62:63]
    buffer_load_dwordx4 v195, s[24:27], s66 offen offset:1024 lds
    s_waitcnt lgkmcnt(0)
    s_nop 0
    v_pk_add_f32 v[16:17], v[16:17], v[64:65]
    v_pk_add_f32 v[18:19], v[18:19], v[66:67]
    v_pk_add_f32 v[20:21], v[20:21], v[68:69]
    v_pk_add_f32 v[22:23], v[22:23], v[70:71]
    v_pk_add_f32 v[24:25], v[24:25], v[72:73]
    v_pk_add_f32 v[26:27], v[26:27], v[74:75]
    v_pk_add_f32 v[28:29], v[28:29], v[76:77]
    v_pk_add_f32 v[30:31], v[30:31], v[78:79]
    s_add_u32 m0, s77, 6144
    s_add_u32 s66, s1, 745472
    buffer_load_dwordx4 v194, s[24:27], s66 offen lds
    v_cvt_pk_bf16_f32 v240, v16, v17
    v_cvt_pk_bf16_f32 v241, v18, v19
    v_cvt_pk_bf16_f32 v242, v20, v21
    v_cvt_pk_bf16_f32 v243, v22, v23
    v_cvt_pk_bf16_f32 v244, v24, v25
    v_cvt_pk_bf16_f32 v245, v26, v27
    v_cvt_pk_bf16_f32 v246, v28, v29
    v_cvt_pk_bf16_f32 v247, v30, v31
    v_dot2c_f32_bf16 v8, s67, v240
    v_dot2c_f32_bf16 v9, v240, v240
    v_dot2c_f32_bf16 v8, s67, v241
    v_dot2c_f32_bf16 v9, v241, v241
    buffer_load_dwordx4 v195, s[24:27], s66 offen offset:1024 lds
    v_dot2c_f32_bf16 v8, s67, v242
    v_dot2c_f32_bf16 v9, v242, v242
    v_dot2c_f32_bf16 v8, s67, v243
    v_dot2c_f32_bf16 v9, v243, v243
    v_dot2c_f32_bf16 v8, s67, v244
    v_dot2c_f32_bf16 v9, v244, v244
    v_dot2c_f32_bf16 v8, s67, v245
    v_dot2c_f32_bf16 v9, v245, v245
    v_dot2c_f32_bf16 v8, s67, v246
    v_dot2c_f32_bf16 v9, v246, v246
    v_dot2c_f32_bf16 v8, s67, v247
    v_dot2c_f32_bf16 v9, v247, v247
    s_nop 1
    v_mov_b32 v10, v8
    v_mov_b32 v11, v9
    s_nop 0
    v_permlane32_swap_b32 v8, v10
    v_permlane32_swap_b32 v9, v11
    v_pk_add_f32 v[8:9], v[8:9], v[10:11]
    v_and_or_b32 v8, v8, v228, s36
    v_and_or_b32 v9, v9, v228, s37
    s_mov_b32 exec_hi, 0
    s_cmp_eq_u32 s71, 0
    s_cbranch_scc0 L_loc_16
    buffer_store_dwordx2 v[8:9], v216, s[16:19], s74 offen sc1
    s_branch L_locj_17
L_loc_16:
    buffer_store_dwordx2 v[8:9], v216, s[16:19], s74 offen
L_locj_17:
    s_mov_b64 exec, -1
    v_lshlrev_b32 v16, 16, v240
    v_and_b32 v17, 0xffff0000, v240
    v_lshlrev_b32 v18, 16, v241
    v_and_b32 v19, 0xffff0000, v241
    v_lshlrev_b32 v20, 16, v242
    v_and_b32 v21, 0xffff0000, v242
    v_lshlrev_b32 v22, 16, v243
    v_and_b32 v23, 0xffff0000, v243
    v_lshlrev_b32 v24, 16, v244
    v_and_b32 v25, 0xffff0000, v244
    v_lshlrev_b32 v26, 16, v245
    v_and_b32 v27, 0xffff0000, v245
    v_lshlrev_b32 v28, 16, v246
    v_and_b32 v29, 0xffff0000, v246
    v_lshlrev_b32 v30, 16, v247
    v_and_b32 v31, 0xffff0000, v247
    s_and_b32 s64, s74, 0xfffff000
    s_mov_b32 s60, 0
L_st_18:
    buffer_load_dwordx2 v[48:49], v217, s[16:19], s64 offen offset:0 sc1
    buffer_load_dwordx2 v[50:51], v217, s[16:19], s64 offen offset:256 sc1
    buffer_load_dwordx2 v[52:53], v217, s[16:19], s64 offen offset:512 sc1
    buffer_load_dwordx2 v[54:55], v217, s[16:19], s64 offen offset:768 sc1
    buffer_load_dwordx2 v[56:57], v217, s[16:19], s64 offen offset:1024 sc1
    buffer_load_dwordx2 v[58:59], v217, s[16:19], s64 offen offset:1280 sc1
    buffer_load_dwordx2 v[60:61], v217, s[16:19], s64 offen offset:1536 sc1
    buffer_load_dwordx2 v[62:63], v217, s[16:19], s64 offen offset:1792 sc1
    s_waitcnt vmcnt(0)
    v_xor_b32 v8, s36, v48
    v_xor_b32_e64 v9, s37, v49
    v_bitop3_b32 v8, v8, v50, s36 bitop3:0xf6
    v_bitop3_b32 v9, v9, v51, s37 bitop3:0xf6
    v_bitop3_b32 v8, v8, v52, s36 bitop3:0xf6
    v_bitop3_b32 v9, v9, v53, s37 bitop3:0xf6
    v_bitop3_b32 v8, v8, v54, s36 bitop3:0xf6
    v_bitop3_b32 v9, v9, v55, s37 bitop3:0xf6
    v_bitop3_b32 v8, v8, v56, s36 bitop3:0xf6
    v_bitop3_b32 v9, v9, v57, s37 bitop3:0xf6
    v_bitop3_b32 v8, v8, v58, s36 bitop3:0xf6
    v_bitop3_b32 v9, v9, v59, s37 bitop3:0xf6
    v_bitop3_b32 v8, v8, v60, s36 bitop3:0xf6
    v_bitop3_b32 v9, v9, v61, s37 bitop3:0xf6
    v_bitop3_b32 v8, v8, v62, s36 bitop3:0xf6
    v_bitop3_b32 v9, v9, v63, s37 bitop3:0xf6
    v_or_b32 v8, v8, v9
    v_and_b32 v8, 15, v8
    v_cmp_ne_u32 vcc, 0, v8
    s_cbranch_vccz L_std_19
    s_add_u32 s60, s60, 1
    s_cmp_lt_u32 s60, 131072
    s_cbranch_scc1 L_st_18
L_std_19:
    v_pk_add_f32 v[48:49], v[48:49], v[56:57]
    v_pk_add_f32 v[50:51], v[50:51], v[58:59]
    v_pk_add_f32 v[52:53], v[52:53], v[60:61]
    v_pk_add_f32 v[54:55], v[54:55], v[62:63]
    v_pk_add_f32 v[48:49], v[48:49], v[52:53]
    v_pk_add_f32 v[50:51], v[50:51], v[54:55]
    v_pk_add_f32 v[48:49], v[48:49], v[50:51]
    s_add_u32 m0, s77, 8192
    s_add_u32 s66, s1, 802816
    buffer_load_dwordx4 v194, s[24:27], s66 offen lds
    v_mov_b32 v50, v48
    v_mov_b32 v51, v49
    s_mov_b32 s63, 0x3b000000
    v_permlane32_swap_b32 v48, v50
    v_permlane32_swap_b32 v49, v51
    v_pk_add_f32 v[48:49], v[48:49], v[50:51]
    v_mul_f32 v8, 0xbb000000, v48
    buffer_load_dwordx4 v195, s[24:27], s66 offen offset:1024 lds
    v_mul_f32 v9, v8, v8
    v_fma_f32 v9, v49, s63, -v9
    v_max_f32 v9, 0, v9
    v_add_f32 v10, 0x3727c5ac, v9
    v_rsq_f32 v10, v10
    s_mov_b32 s63, 0x3727c5ac
    v_mul_f32 v11, v10, v10
    s_add_u32 m0, s77, 10240
    s_add_u32 s66, s1, 860160
    buffer_load_dwordx4 v194, s[24:27], s66 offen lds
    v_fma_f32 v11, v11, v9, s63
    v_rsq_f32 v11, v11
    s_nop 0
    v_mul_f32 v10, v10, v11
    v_mul_f32 v8, v8, v10
    v_pk_fma_f32 v[16:17], v[16:17], v[10:11], v[8:9] op_sel_hi:[1,0,0]
    v_pk_fma_f32 v[18:19], v[18:19], v[10:11], v[8:9] op_sel_hi:[1,0,0]
    v_pk_fma_f32 v[20:21], v[20:21], v[10:11], v[8:9] op_sel_hi:[1,0,0]
    buffer_load_dwordx4 v195, s[24:27], s66 offen offset:1024 lds
    v_pk_fma_f32 v[22:23], v[22:23], v[10:11], v[8:9] op_sel_hi:[1,0,0]
    v_cvt_pk_bf16_f32 v64, v16, v17
    v_cvt_pk_bf16_f32 v65, v18, v19
    v_cvt_pk_bf16_f32 v66, v20, v21
    v_cvt_pk_bf16_f32 v67, v22, v23
    ds_write_b128 v218, v[64:67]
    v_pk_fma_f32 v[24:25], v[24:25], v[10:11], v[8:9] op_sel_hi:[1,0,0]
    s_add_u32 m0, s77, 12288
    s_add_u32 s66, s1, 917504
    buffer_load_dwordx4 v194, s[24:27], s66 offen lds
    v_pk_fma_f32 v[26:27], v[26:27], v[10:11], v[8:9] op_sel_hi:[1,0,0]
    v_pk_fma_f32 v[28:29], v[28:29], v[10:11], v[8:9] op_sel_hi:[1,0,0]
    v_pk_fma_f32 v[30:31], v[30:31], v[10:11], v[8:9] op_sel_hi:[1,0,0]
    v_cvt_pk_bf16_f32 v68, v24, v25
    v_cvt_pk_bf16_f32 v69, v26, v27
    v_cvt_pk_bf16_f32 v70, v28, v29
    v_cvt_pk_bf16_f32 v71, v30, v31
    buffer_load_dwordx4 v195, s[24:27], s66 offen offset:1024 lds
    ds_write_b128 v219, v[68:71]
    s_waitcnt lgkmcnt(0)
    s_nop 0
    ds_read_b64_tr_b16 v[48:49], v220 offset:0
    ds_read_b64_tr_b16 v[50:51], v221 offset:0
    ds_read_b64_tr_b16 v[52:53], v220 offset:1024
    ds_read_b64_tr_b16 v[54:55], v221 offset:1024
    s_add_u32 m0, s77, 14336
    s_add_u32 s66, s1, 974848
    buffer_load_dwordx4 v194, s[24:27], s66 offen lds
    buffer_load_dwordx4 v195, s[24:27], s66 offen offset:1024 lds
    s_waitcnt lgkmcnt(0)
    buffer_store_dwordx4 v[48:51], v3, s[16:19], s75 offen offset:0 sc1
    buffer_store_dwordx4 v[52:55], v3, s[16:19], s75 offen offset:2048 sc1
    s_waitcnt vmcnt(0)
    s_mov_b64 exec, 1
    buffer_store_dword v224, v225, s[16:19], s97 offen sc1
    s_mov_b64 exec, -1
    s_barrier
    s_cmp_eq_u32 s57, 0
    s_cbranch_scc1 L_g1skip_20
    s_lshl_b32 s61, s55, 7
    s_lshl_b32 s62, s58, 6
    s_add_u32 s61, s61, s62
    buffer_load_dwordx2 v[96:97], v222, s[40:43], s61 offen offset:0
    buffer_load_dwordx2 v[98:99], v222, s[40:43], s61 offen offset:16
    buffer_load_dwordx2 v[100:101], v222, s[40:43], s61 offen offset:32
    buffer_load_dwordx2 v[102:103], v222, s[40:43], s61 offen offset:48
    ds_read_b64_tr_b16 a[128:129], v122 offset:4096
    ds_read_b64_tr_b16 a[130:131], v122 offset:4608
    ds_read_b64_tr_b16 a[132:133], v123 offset:4096
    ds_read_b64_tr_b16 a[134:135], v123 offset:4608
    ds_read_b64_tr_b16 a[136:137], v122 offset:6144
    ds_read_b64_tr_b16 a[138:139], v122 offset:6656
    ds_read_b64_tr_b16 a[140:141], v123 offset:6144
    ds_read_b64_tr_b16 a[142:143], v123 offset:6656
    ds_read_b64_tr_b16 a[144:145], v200 offset:0
    ds_read_b64_tr_b16 a[146:147], v200 offset:512
    ds_read_b64_tr_b16 a[148:149], v201 offset:0
    ds_read_b64_tr_b16 a[150:151], v201 offset:512
    ds_read_b64_tr_b16 a[152:153], v200 offset:2048
    ds_read_b64_tr_b16 a[154:155], v200 offset:2560
    ds_read_b64_tr_b16 a[156:157], v201 offset:2048
    ds_read_b64_tr_b16 a[158:159], v201 offset:2560
    ds_read_b64_tr_b16 a[160:161], v200 offset:4096
    ds_read_b64_tr_b16 a[162:163], v200 offset:4608
    ds_read_b64_tr_b16 a[164:165], v201 offset:4096
    ds_read_b64_tr_b16 a[166:167], v201 offset:4608
    ds_read_b64_tr_b16 a[168:169], v200 offset:6144
    ds_read_b64_tr_b16 a[170:171], v200 offset:6656
    ds_read_b64_tr_b16 a[172:173], v201 offset:6144
    ds_read_b64_tr_b16 a[174:175], v201 offset:6656
    ds_read_b64_tr_b16 a[176:177], v200 offset:8192
    ds_read_b64_tr_b16 a[178:179], v200 offset:8704
    ds_read_b64_tr_b16 a[180:181], v201 offset:8192
    ds_read_b64_tr_b16 a[182:183], v201 offset:8704
    ds_read_b64_tr_b16 a[184:185], v200 offset:10240
    ds_read_b64_tr_b16 a[186:187], v200 offset:10752
    ds_read_b64_tr_b16 a[188:189], v201 offset:10240
    ds_read_b64_tr_b16 a[190:191], v201 offset:10752
    ds_read_b64_tr_b16 a[0:1], v200 offset:12288
    ds_read_b64_tr_b16 a[2:3], v200 offset:12800
    ds_read_b64_tr_b16 a[4:5], v201 offset:12288
    ds_read_b64_tr_b16 a[6:7], v201 offset:12800
    ds_read_b64_tr_b16 a[8:9], v200 offset:14336
    ds_read_b64_tr_b16 a[10:11], v200 offset:14848
    ds_read_b64_tr_b16 a[12:13], v201 offset:14336
    ds_read_b64_tr_b16 a[14:15], v201 offset:14848
    s_add_u32 m0, s78, 0
    s_add_u32 s66, s1, 1032192
    buffer_load_dwordx4 v194, s[24:27], s66 offen lds
    buffer_load_dwordx4 v195, s[24:27], s66 offen offset:1024 lds
    s_add_u32 m0, s78, 2048
    s_add_u32 s66, s1, 1089536
    buffer_load_dwordx4 v194, s[24:27], s66 offen lds
    buffer_load_dwordx4 v195, s[24:27], s66 offen offset:1024 lds
    s_waitcnt lgkmcnt(0)
    s_add_u32 m0, s77, 0
    s_nop 0
    s_add_u32 s66, s1, 1146880
    buffer_load_dwordx4 v194, s[24:27], s66 offen lds
    buffer_load_dwordx4 v195, s[24:27], s66 offen offset:1024 lds
    s_add_u32 m0, s77, 2048
    s_add_u32 s66, s1, 1204224
    buffer_load_dwordx4 v194, s[24:27], s66 offen lds
    buffer_load_dwordx4 v195, s[24:27], s66 offen offset:1024 lds
    s_add_u32 m0, s77, 4096
    s_add_u32 s66, s1, 1261568
    buffer_load_dwordx4 v194, s[24:27], s66 offen lds
    buffer_load_dwordx4 v195, s[24:27], s66 offen offset:1024 lds
    s_add_u32 m0, s77, 6144
    s_add_u32 s66, s1, 1318912
    buffer_load_dwordx4 v194, s[24:27], s66 offen lds
    buffer_load_dwordx4 v195, s[24:27], s66 offen offset:1024 lds
    s_add_u32 m0, s77, 8192
    s_add_u32 s66, s1, 1376256
    buffer_load_dwordx4 v194, s[24:27], s66 offen lds
    buffer_load_dwordx4 v195, s[24:27], s66 offen offset:1024 lds
    s_add_u32 m0, s77, 10240
    s_add_u32 s66, s1, 1433600
    buffer_load_dwordx4 v194, s[24:27], s66 offen lds
    buffer_load_dwordx4 v195, s[24:27], s66 offen offset:1024 lds
    s_add_u32 m0, s77, 12288
    s_add_u32 s66, s1, 1490944
    buffer_load_dwordx4 v194, s[24:27], s66 offen lds
    buffer_load_dwordx4 v195, s[24:27], s66 offen offset:1024 lds
    s_lshl_b32 s64, s54, 13
    s_lshl_b32 s62, s48, 19
    s_add_u32 s64, s64, s62
    s_add_u32 s64, s64, 4194304
    s_xor_b32 s65, s64, 8192
    s_bfe_u32 s38, s2, 0x5
    s_mov_b64 exec, 0xff
    s_mov_b32 s60, 0
L_g1_h_22:
    buffer_load_dwordx4 v[88:91], v207, s[16:19], 0 offen sc1
    s_waitcnt vmcnt(0)
    v_xor_b32 v12, s53, v88
    v_bitop3_b32 v12, v12, v89, s53 bitop3:0xf6
    v_bitop3_b32 v12, v12, v90, s53 bitop3:0xf6
    v_bitop3_b32 v12, v12, v91, s53 bitop3:0xf6
    v_cmp_ne_u32 vcc, 0, v12
    s_cbranch_vccz L_g1_hd_23
    s_add_u32 s60, s60, 1
    s_cmp_lt_u32 s60, 131072
    s_cbranch_scc1 L_g1_h_22
L_g1_hd_23:
    s_mov_b64 exec, -1
    s_add_u32 s63, s64, 0
    s_nop 0
    buffer_load_dwordx4 v[128:131], v204, s[16:19], s63 offen offset:0 sc1
    buffer_load_dwordx4 v[132:135], v205, s[16:19], s63 offen offset:0 sc1
    buffer_load_dwordx4 v[136:139], v204, s[16:19], s63 offen offset:2048 sc1
    buffer_load_dwordx4 v[140:143], v205, s[16:19], s63 offen offset:2048 sc1
    s_add_u32 s63, s64, 4096
    buffer_load_dwordx4 v[144:147], v204, s[16:19], s63 offen offset:0 sc1
    buffer_load_dwordx4 v[148:151], v205, s[16:19], s63 offen offset:0 sc1
    buffer_load_dwordx4 v[152:155], v204, s[16:19], s63 offen offset:2048 sc1
    buffer_load_dwordx4 v[156:159], v205, s[16:19], s63 offen offset:2048 sc1
    v_lshlrev_b32 v104, 16, v96
    v_and_b32 v105, 0xffff0000, v96
    v_lshlrev_b32 v106, 16, v97
    v_and_b32 v107, 0xffff0000, v97
    v_lshlrev_b32 v108, 16, v98
    v_and_b32 v109, 0xffff0000, v98
    v_lshlrev_b32 v110, 16, v99
    v_and_b32 v111, 0xffff0000, v99
    v_lshlrev_b32 v112, 16, v100
    v_and_b32 v113, 0xffff0000, v100
    v_lshlrev_b32 v114, 16, v101
    v_and_b32 v115, 0xffff0000, v101
    v_lshlrev_b32 v116, 16, v102
    v_and_b32 v117, 0xffff0000, v102
    v_lshlrev_b32 v118, 16, v103
    v_and_b32 v119, 0xffff0000, v103
    ds_read_b64_tr_b16 a[16:17], v122 offset:0
    ds_read_b64_tr_b16 a[18:19], v122 offset:512
    ds_read_b64_tr_b16 a[20:21], v123 offset:0
    ds_read_b64_tr_b16 a[22:23], v123 offset:512
    ds_read_b64_tr_b16 a[24:25], v122 offset:2048
    ds_read_b64_tr_b16 a[26:27], v122 offset:2560
    ds_read_b64_tr_b16 a[28:29], v123 offset:2048
    ds_read_b64_tr_b16 a[30:31], v123 offset:2560
    ds_read_b64_tr_b16 a[32:33], v200 offset:0
    ds_read_b64_tr_b16 a[34:35], v200 offset:512
    ds_read_b64_tr_b16 a[36:37], v201 offset:0
    ds_read_b64_tr_b16 a[38:39], v201 offset:512
    ds_read_b64_tr_b16 a[40:41], v200 offset:2048
    ds_read_b64_tr_b16 a[42:43], v200 offset:2560
    ds_read_b64_tr_b16 a[44:45], v201 offset:2048
    ds_read_b64_tr_b16 a[46:47], v201 offset:2560
    ds_read_b64_tr_b16 a[48:49], v200 offset:4096
    ds_read_b64_tr_b16 a[50:51], v200 offset:4608
    ds_read_b64_tr_b16 a[52:53], v201 offset:4096
    ds_read_b64_tr_b16 a[54:55], v201 offset:4608
    ds_read_b64_tr_b16 a[56:57], v200 offset:6144
    ds_read_b64_tr_b16 a[58:59], v200 offset:6656
    ds_read_b64_tr_b16 a[60:61], v201 offset:6144
    ds_read_b64_tr_b16 a[62:63], v201 offset:6656
    ds_read_b64_tr_b16 a[192:193], v200 offset:8192
    ds_read_b64_tr_b16 a[194:195], v200 offset:8704
    ds_read_b64_tr_b16 a[196:197], v201 offset:8192
    ds_read_b64_tr_b16 a[198:199], v201 offset:8704
    ds_read_b64_tr_b16 a[200:201], v200 offset:10240
    ds_read_b64_tr_b16 a[202:203], v200 offset:10752
    ds_read_b64_tr_b16 a[204:205], v201 offset:10240
    ds_read_b64_tr_b16 a[206:207], v201 offset:10752
    ds_read_b64_tr_b16 a[208:209], v200 offset:12288
    ds_read_b64_tr_b16 a[210:211], v200 offset:12800
    ds_read_b64_tr_b16 a[212:213], v201 offset:12288
    ds_read_b64_tr_b16 a[214:215], v201 offset:12800
    s_waitcnt vmcnt(6)
    s_nop 0
    v_mfma_f32_32x32x16_bf16 v[16:31], a[64:67], v[128:131], 0
    s_add_u32 s63, s65, 65536
    buffer_load_dwordx4 v[160:163], v204, s[16:19], s63 offen offset:0 sc1
    s_add_u32 m0, s77, 14336
    s_add_u32 s66, s1, 1548288
    buffer_load_dwordx4 v194, s[24:27], s66 offen lds
    v_mfma_f32_32x32x16_bf16 v[48:63], a[68:71], v[128:131], 0
    buffer_load_dwordx4 v[164:167], v205, s[16:19], s63 offen offset:0 sc1
    v_mfma_f32_32x32x16_bf16 v[32:47], a[64:67], v[132:135], 0
    buffer_load_dwordx4 v[168:171], v204, s[16:19], s63 offen offset:2048 sc1
    buffer_load_dwordx4 v195, s[24:27], s66 offen offset:1024 lds
    v_mfma_f32_32x32x16_bf16 v[64:79], a[68:71], v[132:135], 0
    buffer_load_dwordx4 v[172:175], v205, s[16:19], s63 offen offset:2048 sc1
    s_waitcnt vmcnt(10)
    s_nop 0
    v_mfma_f32_32x32x16_bf16 v[16:31], a[72:75], v[136:139], v[16:31]
    s_add_u32 s63, s65, 69632
    buffer_load_dwordx4 v[176:179], v204, s[16:19], s63 offen offset:0 sc1
    s_add_u32 m0, s78, 4096
    s_add_u32 s66, s1, 1605632
    buffer_load_dwordx4 v194, s[24:27], s66 offen lds
    v_mfma_f32_32x32x16_bf16 v[48:63], a[76:79], v[136:139], v[48:63]
    buffer_load_dwordx4 v[180:183], v205, s[16:19], s63 offen offset:0 sc1
    v_mfma_f32_32x32x16_bf16 v[32:47], a[72:75], v[140:143], v[32:47]
    buffer_load_dwordx4 v[184:187], v204, s[16:19], s63 offen offset:2048 sc1
    buffer_load_dwordx4 v195, s[24:27], s66 offen offset:1024 lds
    v_mfma_f32_32x32x16_bf16 v[64:79], a[76:79], v[140:143], v[64:79]
    buffer_load_dwordx4 v[188:191], v205, s[16:19], s63 offen offset:2048 sc1
    s_waitcnt vmcnt(14)
    s_nop 0
    v_mfma_f32_32x32x16_bf16 v[16:31], a[80:83], v[144:147], v[16:31]
    s_add_u32 s63, s64, 131072
    buffer_load_dwordx4 v[128:131], v204, s[16:19], s63 offen offset:0 sc1
    s_add_u32 m0, s78, 6144
    s_add_u32 s66, s1, 1662976
    buffer_load_dwordx4 v194, s[24:27], s66 offen lds
    v_mfma_f32_32x32x16_bf16 v[48:63], a[84:87], v[144:147], v[48:63]
    buffer_load_dwordx4 v[132:135], v205, s[16:19], s63 offen offset:0 sc1
    v_mfma_f32_32x32x16_bf16 v[32:47], a[80:83], v[148:151], v[32:47]
    buffer_load_dwordx4 v[136:139], v204, s[16:19], s63 offen offset:2048 sc1
    buffer_load_dwordx4 v195, s[24:27], s66 offen offset:1024 lds
    v_mfma_f32_32x32x16_bf16 v[64:79], a[84:87], v[148:151], v[64:79]
    buffer_load_dwordx4 v[140:143], v205, s[16:19], s63 offen offset:2048 sc1
    s_waitcnt vmcnt(18)
    v_mfma_f32_32x32x16_bf16 v[16:31], a[88:91], v[152:155], v[16:31]
    s_waitcnt lgkmcnt(0)
    s_add_u32 m0, s77, 0
    s_nop 0
    s_add_u32 s66, s1, 1720320
    buffer_load_dwordx4 v194, s[24:27], s66 offen lds
    v_mfma_f32_32x32x16_bf16 v[48:63], a[92:95], v[152:155], v[48:63]
    s_add_u32 s63, s64, 135168
    buffer_load_dwordx4 v[144:147], v204, s[16:19], s63 offen offset:0 sc1
    v_mfma_f32_32x32x16_bf16 v[32:47], a[88:91], v[156:159], v[32:47]
    buffer_load_dwordx4 v195, s[24:27], s66 offen offset:1024 lds
    v_mfma_f32_32x32x16_bf16 v[64:79], a[92:95], v[156:159], v[64:79]
    buffer_load_dwordx4 v[148:151], v205, s[16:19], s63 offen offset:0 sc1
    s_waitcnt vmcnt(19)
    s_nop 0
    v_mfma_f32_32x32x16_bf16 v[16:31], a[96:99], v[160:163], v[16:31]
    s_add_u32 m0, s77, 2048
    s_add_u32 s66, s1, 1777664
    buffer_load_dwordx4 v194, s[24:27], s66 offen lds
    v_mfma_f32_32x32x16_bf16 v[48:63], a[100:103], v[160:163], v[48:63]
    buffer_load_dwordx4 v[152:155], v204, s[16:19], s63 offen offset:2048 sc1
    v_mfma_f32_32x32x16_bf16 v[32:47], a[96:99], v[164:167], v[32:47]
    buffer_load_dwordx4 v195, s[24:27], s66 offen offset:1024 lds
    v_mfma_f32_32x32x16_bf16 v[64:79], a[100:103], v[164:167], v[64:79]
    buffer_load_dwordx4 v[156:159], v205, s[16:19], s63 offen offset:2048 sc1
    s_waitcnt vmcnt(20)
    s_nop 0
    v_mfma_f32_32x32x16_bf16 v[16:31], a[104:107], v[168:171], v[16:31]
    ds_read_b64_tr_b16 a[216:217], v200 offset:14336
    ds_read_b64_tr_b16 a[218:219], v200 offset:14848
    ds_read_b64_tr_b16 a[220:221], v201 offset:14336
    ds_read_b64_tr_b16 a[222:223], v201 offset:14848
    v_mfma_f32_32x32x16_bf16 v[48:63], a[108:111], v[168:171], v[48:63]
    s_add_u32 s63, s65, 196608
    buffer_load_dwordx4 v[160:163], v204, s[16:19], s63 offen offset:0 sc1
    v_mfma_f32_32x32x16_bf16 v[32:47], a[104:107], v[172:175], v[32:47]
    v_mfma_f32_32x32x16_bf16 v[64:79], a[108:111], v[172:175], v[64:79]
    buffer_load_dwordx4 v[164:167], v205, s[16:19], s63 offen offset:0 sc1
    s_waitcnt vmcnt(19)
    v_mfma_f32_32x32x16_bf16 v[16:31], a[112:115], v[176:179], v[16:31]
    s_waitcnt vmcnt(17)
    ds_read_b64_tr_b16 a[224:225], v122 offset:4096
    ds_read_b64_tr_b16 a[226:227], v122 offset:4608
    ds_read_b64_tr_b16 a[228:229], v123 offset:4096
    ds_read_b64_tr_b16 a[230:231], v123 offset:4608
    v_mfma_f32_32x32x16_bf16 v[48:63], a[116:119], v[176:179], v[48:63]
    buffer_load_dwordx4 v[168:171], v204, s[16:19], s63 offen offset:2048 sc1
    v_mfma_f32_32x32x16_bf16 v[32:47], a[112:115], v[180:183], v[32:47]
    v_mfma_f32_32x32x16_bf16 v[64:79], a[116:119], v[180:183], v[64:79]
    buffer_load_dwordx4 v[172:175], v205, s[16:19], s63 offen offset:2048 sc1
    s_waitcnt vmcnt(18)
    v_mfma_f32_32x32x16_bf16 v[16:31], a[120:123], v[184:187], v[16:31]
    s_waitcnt vmcnt(13)
    ds_read_b64_tr_b16 a[232:233], v122 offset:6144
    ds_read_b64_tr_b16 a[234:235], v122 offset:6656
    ds_read_b64_tr_b16 a[236:237], v123 offset:6144
    ds_read_b64_tr_b16 a[238:239], v123 offset:6656
    v_mfma_f32_32x32x16_bf16 v[48:63], a[124:127], v[184:187], v[48:63]
    s_add_u32 s63, s65, 200704
    buffer_load_dwordx4 v[176:179], v204, s[16:19], s63 offen offset:0 sc1
    v_mfma_f32_32x32x16_bf16 v[32:47], a[120:123], v[188:191], v[32:47]
    v_mfma_f32_32x32x16_bf16 v[64:79], a[124:127], v[188:191], v[64:79]
    buffer_load_dwordx4 v[180:183], v205, s[16:19], s63 offen offset:0 sc1
    v_mfma_f32_32x32x16_bf16 v[16:31], a[128:131], v[128:131], v[16:31]
    s_waitcnt vmcnt(11)
    s_nop 0
    ds_read_b64_tr_b16 a[240:241], v200 offset:0
    ds_read_b64_tr_b16 a[242:243], v200 offset:512
    ds_read_b64_tr_b16 a[244:245], v201 offset:0
    ds_read_b64_tr_b16 a[246:247], v201 offset:512
    v_mfma_f32_32x32x16_bf16 v[48:63], a[132:135], v[128:131], v[48:63]
    buffer_load_dwordx4 v[184:187], v204, s[16:19], s63 offen offset:2048 sc1
    v_mfma_f32_32x32x16_bf16 v[32:47], a[128:131], v[132:135], v[32:47]
    v_mfma_f32_32x32x16_bf16 v[64:79], a[132:135], v[132:135], v[64:79]
    buffer_load_dwordx4 v[188:191], v205, s[16:19], s63 offen offset:2048 sc1
    v_mfma_f32_32x32x16_bf16 v[16:31], a[136:139], v[136:139], v[16:31]
    s_waitcnt vmcnt(9)
    s_nop 0
    ds_read_b64_tr_b16 a[248:249], v200 offset:2048
    ds_read_b64_tr_b16 a[250:251], v200 offset:2560
    ds_read_b64_tr_b16 a[252:253], v201 offset:2048
    ds_read_b64_tr_b16 a[254:255], v201 offset:2560
    v_mfma_f32_32x32x16_bf16 v[48:63], a[140:143], v[136:139], v[48:63]
    s_add_u32 s63, s64, 262144
    buffer_load_dwordx4 v[128:131], v204, s[16:19], s63 offen offset:0 sc1
    v_mfma_f32_32x32x16_bf16 v[32:47], a[136:139], v[140:143], v[32:47]
    v_mfma_f32_32x32x16_bf16 v[64:79], a[140:143], v[140:143], v[64:79]
    buffer_load_dwordx4 v[132:135], v205, s[16:19], s63 offen offset:0 sc1
    v_mfma_f32_32x32x16_bf16 v[16:31], a[144:147], v[144:147], v[16:31]
    v_mfma_f32_32x32x16_bf16 v[48:63], a[148:151], v[144:147], v[48:63]
    buffer_load_dwordx4 v[136:139], v204, s[16:19], s63 offen offset:2048 sc1
    v_mfma_f32_32x32x16_bf16 v[32:47], a[144:147], v[148:151], v[32:47]
    v_mfma_f32_32x32x16_bf16 v[64:79], a[148:151], v[148:151], v[64:79]
    buffer_load_dwordx4 v[140:143], v205, s[16:19], s63 offen offset:2048 sc1
    s_waitcnt vmcnt(12)
    v_mfma_f32_32x32x16_bf16 v[16:31], a[152:155], v[152:155], v[16:31]
    v_mfma_f32_32x32x16_bf16 v[48:63], a[156:159], v[152:155], v[48:63]
    s_add_u32 s63, s64, 266240
    buffer_load_dwordx4 v[144:147], v204, s[16:19], s63 offen offset:0 sc1
    v_mfma_f32_32x32x16_bf16 v[32:47], a[152:155], v[156:159], v[32:47]
    v_mfma_f32_32x32x16_bf16 v[64:79], a[156:159], v[156:159], v[64:79]
    buffer_load_dwordx4 v[148:151], v205, s[16:19], s63 offen offset:0 sc1
    s_waitcnt vmcnt(12)
    v_mfma_f32_32x32x16_bf16 v[16:31], a[160:163], v[160:163], v[16:31]
    v_mfma_f32_32x32x16_bf16 v[48:63], a[164:167], v[160:163], v[48:63]
    buffer_load_dwordx4 v[152:155], v204, s[16:19], s63 offen offset:2048 sc1
    v_mfma_f32_32x32x16_bf16 v[32:47], a[160:163], v[164:167], v[32:47]
    v_mfma_f32_32x32x16_bf16 v[64:79], a[164:167], v[164:167], v[64:79]
    buffer_load_dwordx4 v[156:159], v205, s[16:19], s63 offen offset:2048 sc1
    s_waitcnt vmcnt(12)
    v_mfma_f32_32x32x16_bf16 v[16:31], a[168:171], v[168:171], v[16:31]
    v_mfma_f32_32x32x16_bf16 v[48:63], a[172:175], v[168:171], v[48:63]
    s_add_u32 s63, s65, 327680
    buffer_load_dwordx4 v[160:163], v204, s[16:19], s63 offen offset:0 sc1
    v_mfma_f32_32x32x16_bf16 v[32:47], a[168:171], v[172:175], v[32:47]
    v_mfma_f32_32x32x16_bf16 v[64:79], a[172:175], v[172:175], v[64:79]
    buffer_load_dwordx4 v[164:167], v205, s[16:19], s63 offen offset:0 sc1
    s_waitcnt vmcnt(12)
    v_mfma_f32_32x32x16_bf16 v[16:31], a[176:179], v[176:179], v[16:31]
    v_mfma_f32_32x32x16_bf16 v[48:63], a[180:183], v[176:179], v[48:63]
    buffer_load_dwordx4 v[168:171], v204, s[16:19], s63 offen offset:2048 sc1
    v_mfma_f32_32x32x16_bf16 v[32:47], a[176:179], v[180:183], v[32:47]
    v_mfma_f32_32x32x16_bf16 v[64:79], a[180:183], v[180:183], v[64:79]
    buffer_load_dwordx4 v[172:175], v205, s[16:19], s63 offen offset:2048 sc1
    s_waitcnt vmcnt(12)
    v_mfma_f32_32x32x16_bf16 v[16:31], a[184:187], v[184:187], v[16:31]
    v_mfma_f32_32x32x16_bf16 v[48:63], a[188:191], v[184:187], v[48:63]
    s_add_u32 s63, s65, 331776
    buffer_load_dwordx4 v[176:179], v204, s[16:19], s63 offen offset:0 sc1
    v_mfma_f32_32x32x16_bf16 v[32:47], a[184:187], v[188:191], v[32:47]
    v_mfma_f32_32x32x16_bf16 v[64:79], a[188:191], v[188:191], v[64:79]
    buffer_load_dwordx4 v[180:183], v205, s[16:19], s63 offen offset:0 sc1
    s_waitcnt vmcnt(12)
    v_mfma_f32_32x32x16_bf16 v[16:31], a[0:3], v[128:131], v[16:31]
    v_mfma_f32_32x32x16_bf16 v[48:63], a[4:7], v[128:131], v[48:63]
    buffer_load_dwordx4 v[184:187], v204, s[16:19], s63 offen offset:2048 sc1
    v_mfma_f32_32x32x16_bf16 v[32:47], a[0:3], v[132:135], v[32:47]
    v_mfma_f32_32x32x16_bf16 v[64:79], a[4:7], v[132:135], v[64:79]
    buffer_load_dwordx4 v[188:191], v205, s[16:19], s63 offen offset:2048 sc1
    s_waitcnt vmcnt(12)
    v_mfma_f32_32x32x16_bf16 v[16:31], a[8:11], v[136:139], v[16:31]
    v_mfma_f32_32x32x16_bf16 v[48:63], a[12:15], v[136:139], v[48:63]
    s_add_u32 s63, s64, 393216
    buffer_load_dwordx4 v[128:131], v204, s[16:19], s63 offen offset:0 sc1
    v_mfma_f32_32x32x16_bf16 v[32:47], a[8:11], v[140:143], v[32:47]
    v_mfma_f32_32x32x16_bf16 v[64:79], a[12:15], v[140:143], v[64:79]
    buffer_load_dwordx4 v[132:135], v205, s[16:19], s63 offen offset:0 sc1
    s_waitcnt vmcnt(12)
    v_mfma_f32_32x32x16_bf16 v[16:31], a[16:19], v[144:147], v[16:31]
    v_mfma_f32_32x32x16_bf16 v[48:63], a[20:23], v[144:147], v[48:63]
    buffer_load_dwordx4 v[136:139], v204, s[16:19], s63 offen offset:2048 sc1
    v_mfma_f32_32x32x16_bf16 v[32:47], a[16:19], v[148:151], v[32:47]
    v_mfma_f32_32x32x16_bf16 v[64:79], a[20:23], v[148:151], v[64:79]
    buffer_load_dwordx4 v[140:143], v205, s[16:19], s63 offen offset:2048 sc1
    s_waitcnt vmcnt(12)
    v_mfma_f32_32x32x16_bf16 v[16:31], a[24:27], v[152:155], v[16:31]
    v_mfma_f32_32x32x16_bf16 v[48:63], a[28:31], v[152:155], v[48:63]
    s_add_u32 s63, s64, 397312
    buffer_load_dwordx4 v[144:147], v204, s[16:19], s63 offen offset:0 sc1
    v_mfma_f32_32x32x16_bf16 v[32:47], a[24:27], v[156:159], v[32:47]
    v_mfma_f32_32x32x16_bf16 v[64:79], a[28:31], v[156:159], v[64:79]
    buffer_load_dwordx4 v[148:151], v205, s[16:19], s63 offen offset:0 sc1
    s_waitcnt vmcnt(12)
    v_mfma_f32_32x32x16_bf16 v[16:31], a[32:35], v[160:163], v[16:31]
    v_mfma_f32_32x32x16_bf16 v[48:63], a[36:39], v[160:163], v[48:63]
    buffer_load_dwordx4 v[152:155], v204, s[16:19], s63 offen offset:2048 sc1
    v_mfma_f32_32x32x16_bf16 v[32:47], a[32:35], v[164:167], v[32:47]
    v_mfma_f32_32x32x16_bf16 v[64:79], a[36:39], v[164:167], v[64:79]
    buffer_load_dwordx4 v[156:159], v205, s[16:19], s63 offen offset:2048 sc1
    s_waitcnt vmcnt(12)
    v_mfma_f32_32x32x16_bf16 v[16:31], a[40:43], v[168:171], v[16:31]
    v_mfma_f32_32x32x16_bf16 v[48:63], a[44:47], v[168:171], v[48:63]
    s_add_u32 s63, s65, 458752
    buffer_load_dwordx4 v[160:163], v204, s[16:19], s63 offen offset:0 sc1
    v_mfma_f32_32x32x16_bf16 v[32:47], a[40:43], v[172:175], v[32:47]
    v_mfma_f32_32x32x16_bf16 v[64:79], a[44:47], v[172:175], v[64:79]
    buffer_load_dwordx4 v[164:167], v205, s[16:19], s63 offen offset:0 sc1
    s_waitcnt vmcnt(12)
    v_mfma_f32_32x32x16_bf16 v[16:31], a[48:51], v[176:179], v[16:31]
    v_mfma_f32_32x32x16_bf16 v[48:63], a[52:55], v[176:179], v[48:63]
    buffer_load_dwordx4 v[168:171], v204, s[16:19], s63 offen offset:2048 sc1
    v_mfma_f32_32x32x16_bf16 v[32:47], a[48:51], v[180:183], v[32:47]
    v_mfma_f32_32x32x16_bf16 v[64:79], a[52:55], v[180:183], v[64:79]
    buffer_load_dwordx4 v[172:175], v205, s[16:19], s63 offen offset:2048 sc1
    s_waitcnt vmcnt(12)
    v_mfma_f32_32x32x16_bf16 v[16:31], a[56:59], v[184:187], v[16:31]
    v_mfma_f32_32x32x16_bf16 v[48:63], a[60:63], v[184:187], v[48:63]
    s_add_u32 s63, s65, 462848
    buffer_load_dwordx4 v[176:179], v204, s[16:19], s63 offen offset:0 sc1
    v_mfma_f32_32x32x16_bf16 v[32:47], a[56:59], v[188:191], v[32:47]
    v_mfma_f32_32x32x16_bf16 v[64:79], a[60:63], v[188:191], v[64:79]
    buffer_load_dwordx4 v[180:183], v205, s[16:19], s63 offen offset:0 sc1
    s_waitcnt vmcnt(12)
    v_mfma_f32_32x32x16_bf16 v[16:31], a[192:195], v[128:131], v[16:31]
    s_add_u32 m0, s77, 4096
    s_add_u32 s66, s3, 0
    buffer_load_dwordx4 v196, s[28:31], s66 offen lds
    v_mfma_f32_32x32x16_bf16 v[48:63], a[196:199], v[128:131], v[48:63]
    buffer_load_dwordx4 v[184:187], v204, s[16:19], s63 offen offset:2048 sc1
    v_mfma_f32_32x32x16_bf16 v[32:47], a[192:195], v[132:135], v[32:47]
    v_mfma_f32_32x32x16_bf16 v[64:79], a[196:199], v[132:135], v[64:79]
    buffer_load_dwordx4 v[188:191], v205, s[16:19], s63 offen offset:2048 sc1
    buffer_load_dwordx4 v197, s[28:31], s66 offen offset:1024 lds
    s_waitcnt vmcnt(14)
    v_mfma_f32_32x32x16_bf16 v[16:31], a[200:203], v[136:139], v[16:31]
    s_add_u32 m0, s77, 6144
    s_add_u32 s66, s3, 65536
    buffer_load_dwordx4 v196, s[28:31], s66 offen lds
    v_mfma_f32_32x32x16_bf16 v[48:63], a[204:207], v[136:139], v[48:63]
    v_mfma_f32_32x32x16_bf16 v[32:47], a[200:203], v[140:143], v[32:47]
    buffer_load_dwordx4 v197, s[28:31], s66 offen offset:1024 lds
    v_mfma_f32_32x32x16_bf16 v[64:79], a[204:207], v[140:143], v[64:79]
    s_waitcnt vmcnt(14)
    s_nop 0
    v_mfma_f32_32x32x16_bf16 v[16:31], a[208:211], v[144:147], v[16:31]
    s_add_u32 m0, s77, 8192
    s_add_u32 s66, s3, 131072
    buffer_load_dwordx4 v196, s[28:31], s66 offen lds
    v_mfma_f32_32x32x16_bf16 v[48:63], a[212:215], v[144:147], v[48:63]
    v_mfma_f32_32x32x16_bf16 v[32:47], a[208:211], v[148:151], v[32:47]
    buffer_load_dwordx4 v197, s[28:31], s66 offen offset:1024 lds
    v_mfma_f32_32x32x16_bf16 v[64:79], a[212:215], v[148:151], v[64:79]
    s_waitcnt vmcnt(14) lgkmcnt(0)
    s_nop 0
    v_mfma_f32_32x32x16_bf16 v[16:31], a[216:219], v[152:155], v[16:31]
    s_add_u32 m0, s77, 10240
    s_add_u32 s66, s3, 196608
    buffer_load_dwordx4 v196, s[28:31], s66 offen lds
    v_mfma_f32_32x32x16_bf16 v[48:63], a[220:223], v[152:155], v[48:63]
    v_mfma_f32_32x32x16_bf16 v[32:47], a[216:219], v[156:159], v[32:47]
    buffer_load_dwordx4 v197, s[28:31], s66 offen offset:1024 lds
    v_mfma_f32_32x32x16_bf16 v[64:79], a[220:223], v[156:159], v[64:79]
    s_waitcnt vmcnt(14)
    s_nop 0
    v_mfma_f32_32x32x16_bf16 v[16:31], a[224:227], v[160:163], v[16:31]
    s_add_u32 m0, s77, 12288
    s_add_u32 s66, s3, 262144
    buffer_load_dwordx4 v196, s[28:31], s66 offen lds
    v_mfma_f32_32x32x16_bf16 v[48:63], a[228:231], v[160:163], v[48:63]
    v_mfma_f32_32x32x16_bf16 v[32:47], a[224:227], v[164:167], v[32:47]
    buffer_load_dwordx4 v197, s[28:31], s66 offen offset:1024 lds
    v_mfma_f32_32x32x16_bf16 v[64:79], a[228:231], v[164:167], v[64:79]
    s_waitcnt vmcnt(14)
    v_mfma_f32_32x32x16_bf16 v[16:31], a[232:235], v[168:171], v[16:31]
    s_add_u32 m0, s78, 0
    s_add_u32 s66, s3, 327680
    buffer_load_dwordx4 v196, s[28:31], s66 offen lds
    v_mfma_f32_32x32x16_bf16 v[48:63], a[236:239], v[168:171], v[48:63]
    v_mfma_f32_32x32x16_bf16 v[32:47], a[232:235], v[172:175], v[32:47]
    buffer_load_dwordx4 v197, s[28:31], s66 offen offset:1024 lds
    v_mfma_f32_32x32x16_bf16 v[64:79], a[236:239], v[172:175], v[64:79]
    s_waitcnt vmcnt(14)
    s_nop 0
    v_mfma_f32_32x32x16_bf16 v[16:31], a[240:243], v[176:179], v[16:31]
    s_add_u32 m0, s78, 2048
    s_add_u32 s66, s3, 393216
    buffer_load_dwordx4 v196, s[28:31], s66 offen lds
    v_mfma_f32_32x32x16_bf16 v[48:63], a[244:247], v[176:179], v[48:63]
    v_mfma_f32_32x32x16_bf16 v[32:47], a[240:243], v[180:183], v[32:47]
    buffer_load_dwordx4 v197, s[28:31], s66 offen offset:1024 lds
    v_mfma_f32_32x32x16_bf16 v[64:79], a[244:247], v[180:183], v[64:79]
    s_waitcnt vmcnt(13)
    v_mfma_f32_32x32x16_bf16 v[16:31], a[248:251], v[184:187], v[16:31]
    s_add_u32 m0, s77, 0
    s_add_u32 s66, s3, 458752
    buffer_load_dwordx4 v196, s[28:31], s66 offen lds
    v_mfma_f32_32x32x16_bf16 v[48:63], a[252:255], v[184:187], v[48:63]
    v_mfma_f32_32x32x16_bf16 v[32:47], a[248:251], v[188:191], v[32:47]
    buffer_load_dwordx4 v197, s[28:31], s66 offen offset:1024 lds
    v_mfma_f32_32x32x16_bf16 v[64:79], a[252:255], v[188:191], v[64:79]
    s_nop 9
    s_nop 0
    ds_write_b128 v209, v[32:35] offset:0
    ds_write_b128 v209, v[36:39] offset:1024
    ds_write_b128 v209, v[40:43] offset:2048
    ds_write_b128 v209, v[44:47] offset:3072
    ds_write_b128 v210, v[48:51] offset:0
    ds_write_b128 v210, v[52:55] offset:1024
    ds_write_b128 v210, v[56:59] offset:2048
    ds_write_b128 v210, v[60:63] offset:3072
    ds_write_b128 v211, v[64:67] offset:0
    ds_write_b128 v211, v[68:71] offset:1024
    ds_write_b128 v211, v[72:75] offset:2048
    ds_write_b128 v211, v[76:79] offset:3072
    s_waitcnt lgkmcnt(0)
    s_barrier
    ds_read_b128 v[32:35], v212 offset:0
    ds_read_b128 v[36:39], v212 offset:1024
    ds_read_b128 v[40:43], v212 offset:2048
    ds_read_b128 v[44:47], v212 offset:3072
    ds_read_b128 v[48:51], v212 offset:4096
    ds_read_b128 v[52:55], v212 offset:5120
    ds_read_b128 v[56:59], v212 offset:6144
    ds_read_b128 v[60:63], v212 offset:7168
    ds_read_b128 v[64:67], v212 offset:8192
    ds_read_b128 v[68:71], v212 offset:9216
    ds_read_b128 v[72:75], v212 offset:10240
    ds_read_b128 v[76:79], v212 offset:11264
    v_pk_add_f32 v[16:17], v[16:17], v[104:105]
    v_pk_add_f32 v[18:19], v[18:19], v[106:107]
    v_pk_add_f32 v[20:21], v[20:21], v[108:109]
    v_pk_add_f32 v[22:23], v[22:23], v[110:111]
    v_pk_add_f32 v[24:25], v[24:25], v[112:113]
    v_pk_add_f32 v[26:27], v[26:27], v[114:115]
    v_pk_add_f32 v[28:29], v[28:29], v[116:117]
    v_pk_add_f32 v[30:31], v[30:31], v[118:119]
    s_mov_b32 s36, 0xc0135761
    s_mov_b32 s37, 0xc0135761
    v_mov_b32 v8, 0xbdd2d3e8
    v_mov_b32 v10, 1.0
    s_waitcnt lgkmcnt(8)
    v_pk_add_f32 v[16:17], v[16:17], v[32:33]
    v_pk_add_f32 v[18:19], v[18:19], v[34:35]
    v_pk_add_f32 v[20:21], v[20:21], v[36:37]
    v_pk_add_f32 v[22:23], v[22:23], v[38:39]
    v_pk_add_f32 v[24:25], v[24:25], v[40:41]
    v_pk_add_f32 v[26:27], v[26:27], v[42:43]
    v_pk_add_f32 v[28:29], v[28:29], v[44:45]
    v_pk_add_f32 v[30:31], v[30:31], v[46:47]
    s_add_u32 m0, s77, 2048
    s_add_u32 s66, s3, 524288
    buffer_load_dwordx4 v196, s[28:31], s66 offen lds
    s_waitcnt lgkmcnt(4)
    s_nop 0
    v_pk_add_f32 v[16:17], v[16:17], v[48:49]
    v_pk_add_f32 v[18:19], v[18:19], v[50:51]
    v_pk_add_f32 v[20:21], v[20:21], v[52:53]
    v_pk_add_f32 v[22:23], v[22:23], v[54:55]
    v_pk_add_f32 v[24:25], v[24:25], v[56:57]
    v_pk_add_f32 v[26:27], v[26:27], v[58:59]
    v_pk_add_f32 v[28:29], v[28:29], v[60:61]
    v_pk_add_f32 v[30:31], v[30:31], v[62:63]
    buffer_load_dwordx4 v197, s[28:31], s66 offen offset:1024 lds
    s_waitcnt lgkmcnt(0)
    s_nop 0
    v_pk_add_f32 v[16:17], v[16:17], v[64:65]
    v_pk_add_f32 v[18:19], v[18:19], v[66:67]
    v_pk_add_f32 v[20:21], v[20:21], v[68:69]
    v_pk_add_f32 v[22:23], v[22:23], v[70:71]
    v_pk_add_f32 v[24:25], v[24:25], v[72:73]
    v_pk_add_f32 v[26:27], v[26:27], v[74:75]
    v_pk_add_f32 v[28:29], v[28:29], v[76:77]
    v_pk_add_f32 v[30:31], v[30:31], v[78:79]
    s_add_u32 m0, s77, 14336
    s_add_u32 s66, s3, 589824
    buffer_load_dwordx4 v196, s[28:31], s66 offen lds
    v_pk_mul_f32 v[32:33], v[16:17], v[16:17]
    v_pk_mul_f32 v[34:35], v[18:19], v[18:19]
    v_pk_mul_f32 v[36:37], v[20:21], v[20:21]
    v_pk_mul_f32 v[38:39], v[22:23], v[22:23]
    v_pk_fma_f32 v[32:33], v[32:33], v[8:9], s[36:37] op_sel_hi:[1,0,1]
    v_pk_fma_f32 v[34:35], v[34:35], v[8:9], s[36:37] op_sel_hi:[1,0,1]
    v_pk_fma_f32 v[36:37], v[36:37], v[8:9], s[36:37] op_sel_hi:[1,0,1]
    v_pk_fma_f32 v[38:39], v[38:39], v[8:9], s[36:37] op_sel_hi:[1,0,1]
    v_pk_mul_f32 v[32:33], v[32:33], v[16:17]
    v_pk_mul_f32 v[34:35], v[34:35], v[18:19]
    v_pk_mul_f32 v[36:37], v[36:37], v[20:21]
    v_pk_mul_f32 v[38:39], v[38:39], v[22:23]
    v_exp_f32 v32, v32
    v_exp_f32 v33, v33
    buffer_load_dwordx4 v197, s[28:31], s66 offen offset:1024 lds
    v_exp_f32 v34, v34
    v_exp_f32 v35, v35
    v_exp_f32 v36, v36
    v_exp_f32 v37, v37
    v_exp_f32 v38, v38
    v_exp_f32 v39, v39
    v_pk_add_f32 v[32:33], v[32:33], v[10:11] op_sel_hi:[1,0]
    v_pk_add_f32 v[34:35], v[34:35], v[10:11] op_sel_hi:[1,0]
    v_pk_add_f32 v[36:37], v[36:37], v[10:11] op_sel_hi:[1,0]
    v_pk_add_f32 v[38:39], v[38:39], v[10:11] op_sel_hi:[1,0]
    v_rcp_f32 v32, v32
    v_rcp_f32 v33, v33
    v_rcp_f32 v34, v34
    v_rcp_f32 v35, v35
    s_add_u32 m0, s78, 4096
    s_add_u32 s66, s3, 655360
    buffer_load_dwordx4 v196, s[28:31], s66 offen lds
    v_rcp_f32 v36, v36
    v_rcp_f32 v37, v37
    v_rcp_f32 v38, v38
    v_rcp_f32 v39, v39
    v_pk_mul_f32 v[32:33], v[32:33], v[16:17]
    v_pk_mul_f32 v[34:35], v[34:35], v[18:19]
    v_pk_mul_f32 v[36:37], v[36:37], v[20:21]
    v_pk_mul_f32 v[38:39], v[38:39], v[22:23]
    v_cvt_pk_bf16_f32 v48, v32, v33
    v_cvt_pk_bf16_f32 v49, v34, v35
    v_cvt_pk_bf16_f32 v50, v36, v37
    v_cvt_pk_bf16_f32 v51, v38, v39
    buffer_store_dwordx4 v[48:51], v3, s[16:19], s76 offen sc1
    v_pk_mul_f32 v[40:41], v[24:25], v[24:25]
    buffer_load_dwordx4 v197, s[28:31], s66 offen offset:1024 lds
    v_pk_mul_f32 v[42:43], v[26:27], v[26:27]
    v_pk_mul_f32 v[44:45], v[28:29], v[28:29]
    v_pk_mul_f32 v[46:47], v[30:31], v[30:31]
    v_pk_fma_f32 v[40:41], v[40:41], v[8:9], s[36:37] op_sel_hi:[1,0,1]
    v_pk_fma_f32 v[42:43], v[42:43], v[8:9], s[36:37] op_sel_hi:[1,0,1]
    v_pk_fma_f32 v[44:45], v[44:45], v[8:9], s[36:37] op_sel_hi:[1,0,1]
    v_pk_fma_f32 v[46:47], v[46:47], v[8:9], s[36:37] op_sel_hi:[1,0,1]
    v_pk_mul_f32 v[40:41], v[40:41], v[24:25]
    v_pk_mul_f32 v[42:43], v[42:43], v[26:27]
    v_pk_mul_f32 v[44:45], v[44:45], v[28:29]
    v_pk_mul_f32 v[46:47], v[46:47], v[30:31]
    v_exp_f32 v40, v40
    v_exp_f32 v41, v41
    v_exp_f32 v42, v42
    s_add_u32 m0, s78, 6144
    s_add_u32 s66, s3, 720896
    buffer_load_dwordx4 v196, s[28:31], s66 offen lds
    v_exp_f32 v43, v43
    v_exp_f32 v44, v44
    v_exp_f32 v45, v45
    v_exp_f32 v46, v46
    v_exp_f32 v47, v47
    v_pk_add_f32 v[40:41], v[40:41], v[10:11] op_sel_hi:[1,0]
    v_pk_add_f32 v[42:43], v[42:43], v[10:11] op_sel_hi:[1,0]
    v_pk_add_f32 v[44:45], v[44:45], v[10:11] op_sel_hi:[1,0]
    v_pk_add_f32 v[46:47], v[46:47], v[10:11] op_sel_hi:[1,0]
    v_rcp_f32 v40, v40
    v_rcp_f32 v41, v41
    v_rcp_f32 v42, v42
    v_rcp_f32 v43, v43
    v_rcp_f32 v44, v44
    buffer_load_dwordx4 v197, s[28:31], s66 offen offset:1024 lds
    v_rcp_f32 v45, v45
    v_rcp_f32 v46, v46
    v_rcp_f32 v47, v47
    v_pk_mul_f32 v[40:41], v[40:41], v[24:25]
    v_pk_mul_f32 v[42:43], v[42:43], v[26:27]
    v_pk_mul_f32 v[44:45], v[44:45], v[28:29]
    v_pk_mul_f32 v[46:47], v[46:47], v[30:31]
    v_cvt_pk_bf16_f32 v52, v40, v41
    v_cvt_pk_bf16_f32 v53, v42, v43
    v_cvt_pk_bf16_f32 v54, v44, v45
    v_cvt_pk_bf16_f32 v55, v46, v47
    buffer_store_dwordx4 v[52:55], v3, s[16:19], s76 offen offset:2048 sc1
    s_waitcnt vmcnt(0)
    s_mov_b64 exec, 1
    buffer_store_dword v224, v225, s[16:19], s94 offen sc1
    s_mov_b64 exec, -1
    s_branch L_g1join_21
L_g1skip_20:
    s_waitcnt vmcnt(0)
    s_bfe_u32 s61, s2, 0x20003
    s_bfe_u32 s63, s2, 0x20001
    s_and_b32 s63, s2, 7
    s_mul_i32 s64, s61, 1835008
    s_lshl_b32 s62, s48, 14
    s_add_u32 s64, s64, s62
    s_lshl_b32 s62, s63, 9
    s_add_u32 s64, s64, s62
    v_lshlrev_b32 v14, 4, v1
    v_lshl_add_u32 v14, v2, 12, v14
    s_waitcnt lgkmcnt(0)
    s_lshl_b32 s61, s48, 10
    s_add_u32 m0, s61, 57344
    s_mov_b32 s60, 26
L_idle_24:
    s_add_u32 s61, s64, 0
    buffer_load_dwordx4 v14, s[28:31], s61 offen lds
    s_add_u32 s61, s64, 8192
    buffer_load_dwordx4 v14, s[28:31], s61 offen lds
    s_add_u32 s64, s64, 65536
    s_sub_u32 s60, s60, 1
    s_cmp_lg_u32 s60, 0
    s_cbranch_scc1 L_idle_24
    s_add_u32 m0, s77, 4096
    s_add_u32 s66, s3, 0
    s_nop 0
    buffer_load_dwordx4 v196, s[28:31], s66 offen lds
    buffer_load_dwordx4 v197, s[28:31], s66 offen offset:1024 lds
    s_add_u32 m0, s77, 6144
    s_add_u32 s66, s3, 65536
    buffer_load_dwordx4 v196, s[28:31], s66 offen lds
    buffer_load_dwordx4 v197, s[28:31], s66 offen offset:1024 lds
    s_add_u32 m0, s77, 8192
    s_add_u32 s66, s3, 131072
    buffer_load_dwordx4 v196, s[28:31], s66 offen lds
    buffer_load_dwordx4 v197, s[28:31], s66 offen offset:1024 lds
    s_add_u32 m0, s77, 10240
    s_add_u32 s66, s3, 196608
    buffer_load_dwordx4 v196, s[28:31], s66 offen lds
    buffer_load_dwordx4 v197, s[28:31], s66 offen offset:1024 lds
    s_add_u32 m0, s77, 12288
    s_add_u32 s66, s3, 262144
    buffer_load_dwordx4 v196, s[28:31], s66 offen lds
    buffer_load_dwordx4 v197, s[28:31], s66 offen offset:1024 lds
    s_add_u32 m0, s78, 0
    s_add_u32 s66, s3, 327680
    buffer_load_dwordx4 v196, s[28:31], s66 offen lds
    buffer_load_dwordx4 v197, s[28:31], s66 offen offset:1024 lds
    s_add_u32 m0, s78, 2048
    s_add_u32 s66, s3, 393216
    buffer_load_dwordx4 v196, s[28:31], s66 offen lds
    buffer_load_dwordx4 v197, s[28:31], s66 offen offset:1024 lds
    s_add_u32 m0, s77, 0
    s_add_u32 s66, s3, 458752
    buffer_load_dwordx4 v196, s[28:31], s66 offen lds
    buffer_load_dwordx4 v197, s[28:31], s66 offen offset:1024 lds
    s_add_u32 m0, s77, 2048
    s_add_u32 s66, s3, 524288
    buffer_load_dwordx4 v196, s[28:31], s66 offen lds
    buffer_load_dwordx4 v197, s[28:31], s66 offen offset:1024 lds
    s_add_u32 m0, s77, 14336
    s_add_u32 s66, s3, 589824
    buffer_load_dwordx4 v196, s[28:31], s66 offen lds
    buffer_load_dwordx4 v197, s[28:31], s66 offen offset:1024 lds
    s_add_u32 m0, s78, 4096
    s_add_u32 s66, s3, 655360
    buffer_load_dwordx4 v196, s[28:31], s66 offen lds
    buffer_load_dwordx4 v197, s[28:31], s66 offen offset:1024 lds
    s_add_u32 m0, s78, 6144
    s_add_u32 s66, s3, 720896
    buffer_load_dwordx4 v196, s[28:31], s66 offen lds
    buffer_load_dwordx4 v197, s[28:31], s66 offen offset:1024 lds
    s_waitcnt vmcnt(0) lgkmcnt(0)
L_g1join_21:
    s_lshl_b32 s61, s56, 7
    s_lshl_b32 s62, s59, 6
    s_add_u32 s61, s61, s62
    buffer_load_ushort v120, v223, s[44:47], s61 offen
    s_xor_b32 s61, s58, s59
    s_lshl_b32 s61, s61, 10
    v_xor_b32 v204, s61, v204
    v_xor_b32 v205, s61, v205
    ds_read_b64_tr_b16 a[64:65], v198 offset:4096
    ds_read_b64_tr_b16 a[66:67], v198 offset:5120
    ds_read_b64_tr_b16 a[68:69], v199 offset:4096
    ds_read_b64_tr_b16 a[70:71], v199 offset:5120
    ds_read_b64_tr_b16 a[72:73], v198 offset:6144
    ds_read_b64_tr_b16 a[74:75], v198 offset:7168
    ds_read_b64_tr_b16 a[76:77], v199 offset:6144
    ds_read_b64_tr_b16 a[78:79], v199 offset:7168
    ds_read_b64_tr_b16 a[80:81], v198 offset:8192
    ds_read_b64_tr_b16 a[82:83], v198 offset:9216
    ds_read_b64_tr_b16 a[84:85], v199 offset:8192
    ds_read_b64_tr_b16 a[86:87], v199 offset:9216
    ds_read_b64_tr_b16 a[88:89], v198 offset:10240
    ds_read_b64_tr_b16 a[90:91], v198 offset:11264
    ds_read_b64_tr_b16 a[92:93], v199 offset:10240
    ds_read_b64_tr_b16 a[94:95], v199 offset:11264
    ds_read_b64_tr_b16 a[96:97], v198 offset:12288
    ds_read_b64_tr_b16 a[98:99], v198 offset:13312
    ds_read_b64_tr_b16 a[100:101], v199 offset:12288
    ds_read_b64_tr_b16 a[102:103], v199 offset:13312
    ds_read_b64_tr_b16 a[104:105], v202 offset:0
    ds_read_b64_tr_b16 a[106:107], v202 offset:1024
    ds_read_b64_tr_b16 a[108:109], v203 offset:0
    ds_read_b64_tr_b16 a[110:111], v203 offset:1024
    ds_read_b64_tr_b16 a[112:113], v202 offset:2048
    ds_read_b64_tr_b16 a[114:115], v202 offset:3072
    ds_read_b64_tr_b16 a[116:117], v203 offset:2048
    ds_read_b64_tr_b16 a[118:119], v203 offset:3072
    ds_read_b64_tr_b16 a[120:121], v198 offset:0
    ds_read_b64_tr_b16 a[122:123], v198 offset:1024
    ds_read_b64_tr_b16 a[124:125], v199 offset:0
    ds_read_b64_tr_b16 a[126:127], v199 offset:1024
    ds_read_b64_tr_b16 a[128:129], v198 offset:2048
    ds_read_b64_tr_b16 a[130:131], v198 offset:3072
    ds_read_b64_tr_b16 a[132:133], v199 offset:2048
    ds_read_b64_tr_b16 a[134:135], v199 offset:3072
    ds_read_b64_tr_b16 a[136:137], v198 offset:14336
    ds_read_b64_tr_b16 a[138:139], v198 offset:15360
    ds_read_b64_tr_b16 a[140:141], v199 offset:14336
    ds_read_b64_tr_b16 a[142:143], v199 offset:15360
    ds_read_b64_tr_b16 a[144:145], v202 offset:4096
    ds_read_b64_tr_b16 a[146:147], v202 offset:5120
    ds_read_b64_tr_b16 a[148:149], v203 offset:4096
    ds_read_b64_tr_b16 a[150:151], v203 offset:5120
    ds_read_b64_tr_b16 a[152:153], v202 offset:6144
    ds_read_b64_tr_b16 a[154:155], v202 offset:7168
    ds_read_b64_tr_b16 a[156:157], v203 offset:6144
    ds_read_b64_tr_b16 a[158:159], v203 offset:7168
    s_waitcnt lgkmcnt(0)
    s_add_u32 m0, s77, 0
    s_add_u32 s66, s3, 786432
    buffer_load_dwordx4 v196, s[28:31], s66 offen lds
    buffer_load_dwordx4 v197, s[28:31], s66 offen offset:1024 lds
    s_add_u32 m0, s77, 2048
    s_add_u32 s66, s3, 851968
    buffer_load_dwordx4 v196, s[28:31], s66 offen lds
    buffer_load_dwordx4 v197, s[28:31], s66 offen offset:1024 lds
    s_add_u32 m0, s77, 4096
    s_add_u32 s66, s3, 917504
    buffer_load_dwordx4 v196, s[28:31], s66 offen lds
    buffer_load_dwordx4 v197, s[28:31], s66 offen offset:1024 lds
    s_add_u32 m0, s77, 6144
    s_add_u32 s66, s3, 983040
    buffer_load_dwordx4 v196, s[28:31], s66 offen lds
    buffer_load_dwordx4 v197, s[28:31], s66 offen offset:1024 lds
    s_add_u32 m0, s77, 8192
    s_add_u32 s66, s3, 1048576
    buffer_load_dwordx4 v196, s[28:31], s66 offen lds
    buffer_load_dwordx4 v197, s[28:31], s66 offen offset:1024 lds
    s_add_u32 m0, s77, 10240
    s_add_u32 s66, s3, 1114112
    buffer_load_dwordx4 v196, s[28:31], s66 offen lds
    buffer_load_dwordx4 v197, s[28:31], s66 offen offset:1024 lds
    s_add_u32 m0, s77, 12288
    s_add_u32 s66, s3, 1179648
    buffer_load_dwordx4 v196, s[28:31], s66 offen lds
    buffer_load_dwordx4 v197, s[28:31], s66 offen offset:1024 lds
    s_add_u32 m0, s77, 14336
    s_add_u32 s66, s3, 1245184
    buffer_load_dwordx4 v196, s[28:31], s66 offen lds
    buffer_load_dwordx4 v197, s[28:31], s66 offen offset:1024 lds
    s_add_u32 m0, s78, 0
    s_add_u32 s66, s3, 1310720
    buffer_load_dwordx4 v196, s[28:31], s66 offen lds
    buffer_load_dwordx4 v197, s[28:31], s66 offen offset:1024 lds
    s_barrier
    s_mul_i32 s64, s50, 229376
    s_mul_i32 s62, s48, 57344
    s_add_u32 s64, s64, s62
    s_add_u32 s64, s64, 1048576
    s_and_b32 s38, s49, 0
    s_mov_b64 exec, 0xff
    s_mov_b32 s60, 0
L_g2_h_25:
    buffer_load_dwordx4 v[88:91], v208, s[16:19], 0 offen sc1
    s_waitcnt vmcnt(0)
    v_xor_b32 v12, s53, v88
    v_bitop3_b32 v12, v12, v89, s53 bitop3:0xf6
    v_bitop3_b32 v12, v12, v90, s53 bitop3:0xf6
    v_bitop3_b32 v12, v12, v91, s53 bitop3:0xf6
    v_cmp_ne_u32 vcc, 0, v12
    s_cbranch_vccz L_g2_hd_26
    s_add_u32 s60, s60, 1
    s_cmp_lt_u32 s60, 131072
    s_cbranch_scc1 L_g2_h_25
L_g2_hd_26:
    s_mov_b64 exec, -1
    s_add_u32 s63, s64, 0
    s_nop 0
    buffer_load_dwordx4 v[128:131], v204, s[16:19], s63 offen offset:0 sc1
    buffer_load_dwordx4 v[132:135], v205, s[16:19], s63 offen offset:0 sc1
    buffer_load_dwordx4 v[136:139], v204, s[16:19], s63 offen offset:2048 sc1
    buffer_load_dwordx4 v[140:143], v205, s[16:19], s63 offen offset:2048 sc1
    s_add_u32 s63, s64, 4096
    buffer_load_dwordx4 v[144:147], v204, s[16:19], s63 offen offset:0 sc1
    buffer_load_dwordx4 v[148:151], v205, s[16:19], s63 offen offset:0 sc1
    buffer_load_dwordx4 v[152:155], v204, s[16:19], s63 offen offset:2048 sc1
    buffer_load_dwordx4 v[156:159], v205, s[16:19], s63 offen offset:2048 sc1
    ds_read_b64_tr_b16 a[160:161], v198 offset:0
    ds_read_b64_tr_b16 a[162:163], v198 offset:1024
    ds_read_b64_tr_b16 a[164:165], v199 offset:0
    ds_read_b64_tr_b16 a[166:167], v199 offset:1024
    ds_read_b64_tr_b16 a[168:169], v198 offset:2048
    ds_read_b64_tr_b16 a[170:171], v198 offset:3072
    ds_read_b64_tr_b16 a[172:173], v199 offset:2048
    ds_read_b64_tr_b16 a[174:175], v199 offset:3072
    ds_read_b64_tr_b16 a[176:177], v198 offset:4096
    ds_read_b64_tr_b16 a[178:179], v198 offset:5120
    ds_read_b64_tr_b16 a[180:181], v199 offset:4096
    ds_read_b64_tr_b16 a[182:183], v199 offset:5120
    ds_read_b64_tr_b16 a[184:185], v198 offset:6144
    ds_read_b64_tr_b16 a[186:187], v198 offset:7168
    ds_read_b64_tr_b16 a[188:189], v199 offset:6144
    ds_read_b64_tr_b16 a[190:191], v199 offset:7168
    ds_read_b64_tr_b16 a[0:1], v198 offset:8192
    ds_read_b64_tr_b16 a[2:3], v198 offset:9216
    ds_read_b64_tr_b16 a[4:5], v199 offset:8192
    ds_read_b64_tr_b16 a[6:7], v199 offset:9216
    ds_read_b64_tr_b16 a[8:9], v198 offset:10240
    ds_read_b64_tr_b16 a[10:11], v198 offset:11264
    ds_read_b64_tr_b16 a[12:13], v199 offset:10240
    ds_read_b64_tr_b16 a[14:15], v199 offset:11264
    ds_read_b64_tr_b16 a[16:17], v198 offset:12288
    ds_read_b64_tr_b16 a[18:19], v198 offset:13312
    ds_read_b64_tr_b16 a[20:21], v199 offset:12288
    ds_read_b64_tr_b16 a[22:23], v199 offset:13312
    ds_read_b64_tr_b16 a[24:25], v198 offset:14336
    ds_read_b64_tr_b16 a[26:27], v198 offset:15360
    ds_read_b64_tr_b16 a[28:29], v199 offset:14336
    ds_read_b64_tr_b16 a[30:31], v199 offset:15360
    ds_read_b64_tr_b16 a[32:33], v202 offset:0
    ds_read_b64_tr_b16 a[34:35], v202 offset:1024
    ds_read_b64_tr_b16 a[36:37], v203 offset:0
    ds_read_b64_tr_b16 a[38:39], v203 offset:1024
    s_waitcnt vmcnt(6)
    s_nop 0
    v_mfma_f32_32x32x16_bf16 v[16:31], v[128:131], a[64:67], 0
    s_add_u32 s63, s64, 8192
    buffer_load_dwordx4 v[160:163], v204, s[16:19], s63 offen offset:0 sc1
    s_add_u32 m0, s78, 2048
    s_add_u32 s66, s3, 1376256
    buffer_load_dwordx4 v196, s[28:31], s66 offen lds
    v_mfma_f32_32x32x16_bf16 v[48:63], v[128:131], a[68:71], 0
    buffer_load_dwordx4 v[164:167], v205, s[16:19], s63 offen offset:0 sc1
    v_mfma_f32_32x32x16_bf16 v[32:47], v[132:135], a[64:67], 0
    buffer_load_dwordx4 v[168:171], v204, s[16:19], s63 offen offset:2048 sc1
    buffer_load_dwordx4 v197, s[28:31], s66 offen offset:1024 lds
    v_mfma_f32_32x32x16_bf16 v[64:79], v[132:135], a[68:71], 0
    buffer_load_dwordx4 v[172:175], v205, s[16:19], s63 offen offset:2048 sc1
    s_waitcnt vmcnt(10)
    s_nop 0
    v_mfma_f32_32x32x16_bf16 v[16:31], v[136:139], a[72:75], v[16:31]
    s_add_u32 s63, s64, 12288
    buffer_load_dwordx4 v[176:179], v204, s[16:19], s63 offen offset:0 sc1
    s_add_u32 m0, s78, 4096
    s_add_u32 s66, s3, 1441792
    buffer_load_dwordx4 v196, s[28:31], s66 offen lds
    v_mfma_f32_32x32x16_bf16 v[48:63], v[136:139], a[76:79], v[48:63]
    buffer_load_dwordx4 v[180:183], v205, s[16:19], s63 offen offset:0 sc1
    v_mfma_f32_32x32x16_bf16 v[32:47], v[140:143], a[72:75], v[32:47]
    buffer_load_dwordx4 v[184:187], v204, s[16:19], s63 offen offset:2048 sc1
    buffer_load_dwordx4 v197, s[28:31], s66 offen offset:1024 lds
    v_mfma_f32_32x32x16_bf16 v[64:79], v[140:143], a[76:79], v[64:79]
    buffer_load_dwordx4 v[188:191], v205, s[16:19], s63 offen offset:2048 sc1
    s_waitcnt vmcnt(14)
    s_nop 0
    v_mfma_f32_32x32x16_bf16 v[16:31], v[144:147], a[80:83], v[16:31]
    s_add_u32 s63, s64, 16384
    buffer_load_dwordx4 v[128:131], v204, s[16:19], s63 offen offset:0 sc1
    s_add_u32 m0, s78, 6144
    s_add_u32 s66, s3, 1507328
    buffer_load_dwordx4 v196, s[28:31], s66 offen lds
    v_mfma_f32_32x32x16_bf16 v[48:63], v[144:147], a[84:87], v[48:63]
    buffer_load_dwordx4 v[132:135], v205, s[16:19], s63 offen offset:0 sc1
    v_mfma_f32_32x32x16_bf16 v[32:47], v[148:151], a[80:83], v[32:47]
    buffer_load_dwordx4 v[136:139], v204, s[16:19], s63 offen offset:2048 sc1
    buffer_load_dwordx4 v197, s[28:31], s66 offen offset:1024 lds
    v_mfma_f32_32x32x16_bf16 v[64:79], v[148:151], a[84:87], v[64:79]
    buffer_load_dwordx4 v[140:143], v205, s[16:19], s63 offen offset:2048 sc1
    s_waitcnt vmcnt(18)
    v_mfma_f32_32x32x16_bf16 v[16:31], v[152:155], a[88:91], v[16:31]
    s_waitcnt lgkmcnt(0)
    s_add_u32 m0, s77, 0
    s_nop 0
    s_add_u32 s66, s3, 1572864
    buffer_load_dwordx4 v196, s[28:31], s66 offen lds
    v_mfma_f32_32x32x16_bf16 v[48:63], v[152:155], a[92:95], v[48:63]
    s_add_u32 s63, s64, 20480
    buffer_load_dwordx4 v[144:147], v204, s[16:19], s63 offen offset:0 sc1
    v_mfma_f32_32x32x16_bf16 v[32:47], v[156:159], a[88:91], v[32:47]
    buffer_load_dwordx4 v197, s[28:31], s66 offen offset:1024 lds
    v_mfma_f32_32x32x16_bf16 v[64:79], v[156:159], a[92:95], v[64:79]
    buffer_load_dwordx4 v[148:151], v205, s[16:19], s63 offen offset:0 sc1
    s_waitcnt vmcnt(19)
    s_nop 0
    v_mfma_f32_32x32x16_bf16 v[16:31], v[160:163], a[96:99], v[16:31]
    s_add_u32 m0, s77, 2048
    s_add_u32 s66, s3, 1638400
    buffer_load_dwordx4 v196, s[28:31], s66 offen lds
    v_mfma_f32_32x32x16_bf16 v[48:63], v[160:163], a[100:103], v[48:63]
    buffer_load_dwordx4 v[152:155], v204, s[16:19], s63 offen offset:2048 sc1
    v_mfma_f32_32x32x16_bf16 v[32:47], v[164:167], a[96:99], v[32:47]
    buffer_load_dwordx4 v197, s[28:31], s66 offen offset:1024 lds
    v_mfma_f32_32x32x16_bf16 v[64:79], v[164:167], a[100:103], v[64:79]
    buffer_load_dwordx4 v[156:159], v205, s[16:19], s63 offen offset:2048 sc1
    s_waitcnt vmcnt(20)
    s_nop 0
    v_mfma_f32_32x32x16_bf16 v[16:31], v[168:171], a[104:107], v[16:31]
    s_add_u32 m0, s77, 4096
    s_add_u32 s66, s3, 1703936
    buffer_load_dwordx4 v196, s[28:31], s66 offen lds
    v_mfma_f32_32x32x16_bf16 v[48:63], v[168:171], a[108:111], v[48:63]
    s_add_u32 s63, s64, 24576
    buffer_load_dwordx4 v[160:163], v204, s[16:19], s63 offen offset:0 sc1
    v_mfma_f32_32x32x16_bf16 v[32:47], v[172:175], a[104:107], v[32:47]
    ds_read_b64_tr_b16 a[40:41], v202 offset:2048
    ds_read_b64_tr_b16 a[42:43], v202 offset:3072
    ds_read_b64_tr_b16 a[44:45], v203 offset:2048
    ds_read_b64_tr_b16 a[46:47], v203 offset:3072
    v_mfma_f32_32x32x16_bf16 v[64:79], v[172:175], a[108:111], v[64:79]
    buffer_load_dwordx4 v[164:167], v205, s[16:19], s63 offen offset:0 sc1
    buffer_load_dwordx4 v197, s[28:31], s66 offen offset:1024 lds
    s_waitcnt vmcnt(21)
    v_mfma_f32_32x32x16_bf16 v[16:31], v[176:179], a[112:115], v[16:31]
    s_add_u32 m0, s77, 6144
    s_add_u32 s66, s3, 1769472
    buffer_load_dwordx4 v196, s[28:31], s66 offen lds
    v_mfma_f32_32x32x16_bf16 v[48:63], v[176:179], a[116:119], v[48:63]
    buffer_load_dwordx4 v[168:171], v204, s[16:19], s63 offen offset:2048 sc1
    v_mfma_f32_32x32x16_bf16 v[32:47], v[180:183], a[112:115], v[32:47]
    s_waitcnt vmcnt(21)
    ds_read_b64_tr_b16 a[48:49], v202 offset:4096
    ds_read_b64_tr_b16 a[50:51], v202 offset:5120
    ds_read_b64_tr_b16 a[52:53], v203 offset:4096
    ds_read_b64_tr_b16 a[54:55], v203 offset:5120
    v_mfma_f32_32x32x16_bf16 v[64:79], v[180:183], a[116:119], v[64:79]
    buffer_load_dwordx4 v[172:175], v205, s[16:19], s63 offen offset:2048 sc1
    buffer_load_dwordx4 v197, s[28:31], s66 offen offset:1024 lds
    s_waitcnt vmcnt(22)
    v_mfma_f32_32x32x16_bf16 v[16:31], v[184:187], a[120:123], v[16:31]
    s_waitcnt vmcnt(17)
    ds_read_b64_tr_b16 a[56:57], v202 offset:6144
    ds_read_b64_tr_b16 a[58:59], v202 offset:7168
    ds_read_b64_tr_b16 a[60:61], v203 offset:6144
    ds_read_b64_tr_b16 a[62:63], v203 offset:7168
    v_mfma_f32_32x32x16_bf16 v[48:63], v[184:187], a[124:127], v[48:63]
    s_add_u32 s63, s64, 28672
    buffer_load_dwordx4 v[176:179], v204, s[16:19], s63 offen offset:0 sc1
    v_mfma_f32_32x32x16_bf16 v[32:47], v[188:191], a[120:123], v[32:47]
    v_mfma_f32_32x32x16_bf16 v[64:79], v[188:191], a[124:127], v[64:79]
    buffer_load_dwordx4 v[180:183], v205, s[16:19], s63 offen offset:0 sc1
    v_mfma_f32_32x32x16_bf16 v[16:31], v[128:131], a[128:131], v[16:31]
    s_waitcnt vmcnt(15)
    s_nop 0
    ds_read_b64_tr_b16 a[192:193], v198 offset:0
    ds_read_b64_tr_b16 a[194:195], v198 offset:1024
    ds_read_b64_tr_b16 a[196:197], v199 offset:0
    ds_read_b64_tr_b16 a[198:199], v199 offset:1024
    v_mfma_f32_32x32x16_bf16 v[48:63], v[128:131], a[132:135], v[48:63]
    buffer_load_dwordx4 v[184:187], v204, s[16:19], s63 offen offset:2048 sc1
    v_mfma_f32_32x32x16_bf16 v[32:47], v[132:135], a[128:131], v[32:47]
    v_mfma_f32_32x32x16_bf16 v[64:79], v[132:135], a[132:135], v[64:79]
    buffer_load_dwordx4 v[188:191], v205, s[16:19], s63 offen offset:2048 sc1
    v_mfma_f32_32x32x16_bf16 v[16:31], v[136:139], a[136:139], v[16:31]
    s_waitcnt vmcnt(13)
    s_nop 0
    ds_read_b64_tr_b16 a[200:201], v198 offset:2048
    ds_read_b64_tr_b16 a[202:203], v198 offset:3072
    ds_read_b64_tr_b16 a[204:205], v199 offset:2048
    ds_read_b64_tr_b16 a[206:207], v199 offset:3072
    v_mfma_f32_32x32x16_bf16 v[48:63], v[136:139], a[140:143], v[48:63]
    s_add_u32 s63, s64, 32768
    buffer_load_dwordx4 v[128:131], v204, s[16:19], s63 offen offset:0 sc1
    v_mfma_f32_32x32x16_bf16 v[32:47], v[140:143], a[136:139], v[32:47]
    v_mfma_f32_32x32x16_bf16 v[64:79], v[140:143], a[140:143], v[64:79]
    buffer_load_dwordx4 v[132:135], v205, s[16:19], s63 offen offset:0 sc1
    v_mfma_f32_32x32x16_bf16 v[16:31], v[144:147], a[144:147], v[16:31]
    s_waitcnt vmcnt(10)
    s_nop 0
    ds_read_b64_tr_b16 a[208:209], v198 offset:4096
    ds_read_b64_tr_b16 a[210:211], v198 offset:5120
    ds_read_b64_tr_b16 a[212:213], v199 offset:4096
    ds_read_b64_tr_b16 a[214:215], v199 offset:5120
    v_mfma_f32_32x32x16_bf16 v[48:63], v[144:147], a[148:151], v[48:63]
    buffer_load_dwordx4 v[136:139], v204, s[16:19], s63 offen offset:2048 sc1
    v_mfma_f32_32x32x16_bf16 v[32:47], v[148:151], a[144:147], v[32:47]
    v_mfma_f32_32x32x16_bf16 v[64:79], v[148:151], a[148:151], v[64:79]
    buffer_load_dwordx4 v[140:143], v205, s[16:19], s63 offen offset:2048 sc1
    v_mfma_f32_32x32x16_bf16 v[16:31], v[152:155], a[152:155], v[16:31]
    s_waitcnt vmcnt(8)
    s_nop 0
    ds_read_b64_tr_b16 a[216:217], v198 offset:6144
    ds_read_b64_tr_b16 a[218:219], v198 offset:7168
    ds_read_b64_tr_b16 a[220:221], v199 offset:6144
    ds_read_b64_tr_b16 a[222:223], v199 offset:7168
    v_mfma_f32_32x32x16_bf16 v[48:63], v[152:155], a[156:159], v[48:63]
    s_add_u32 s63, s64, 36864
    buffer_load_dwordx4 v[144:147], v204, s[16:19], s63 offen offset:0 sc1
    v_mfma_f32_32x32x16_bf16 v[32:47], v[156:159], a[152:155], v[32:47]
    v_mfma_f32_32x32x16_bf16 v[64:79], v[156:159], a[156:159], v[64:79]
    buffer_load_dwordx4 v[148:151], v205, s[16:19], s63 offen offset:0 sc1
    v_mfma_f32_32x32x16_bf16 v[16:31], v[160:163], a[160:163], v[16:31]
    v_mfma_f32_32x32x16_bf16 v[48:63], v[160:163], a[164:167], v[48:63]
    buffer_load_dwordx4 v[152:155], v204, s[16:19], s63 offen offset:2048 sc1
    v_mfma_f32_32x32x16_bf16 v[32:47], v[164:167], a[160:163], v[32:47]
    v_mfma_f32_32x32x16_bf16 v[64:79], v[164:167], a[164:167], v[64:79]
    buffer_load_dwordx4 v[156:159], v205, s[16:19], s63 offen offset:2048 sc1
    v_mfma_f32_32x32x16_bf16 v[16:31], v[168:171], a[168:171], v[16:31]
    v_mfma_f32_32x32x16_bf16 v[48:63], v[168:171], a[172:175], v[48:63]
    s_add_u32 s63, s64, 40960
    buffer_load_dwordx4 v[160:163], v204, s[16:19], s63 offen offset:0 sc1
    v_mfma_f32_32x32x16_bf16 v[32:47], v[172:175], a[168:171], v[32:47]
    v_mfma_f32_32x32x16_bf16 v[64:79], v[172:175], a[172:175], v[64:79]
    buffer_load_dwordx4 v[164:167], v205, s[16:19], s63 offen offset:0 sc1
    s_waitcnt vmcnt(12)
    v_mfma_f32_32x32x16_bf16 v[16:31], v[176:179], a[176:179], v[16:31]
    v_mfma_f32_32x32x16_bf16 v[48:63], v[176:179], a[180:183], v[48:63]
    buffer_load_dwordx4 v[168:171], v204, s[16:19], s63 offen offset:2048 sc1
    v_mfma_f32_32x32x16_bf16 v[32:47], v[180:183], a[176:179], v[32:47]
    v_mfma_f32_32x32x16_bf16 v[64:79], v[180:183], a[180:183], v[64:79]
    buffer_load_dwordx4 v[172:175], v205, s[16:19], s63 offen offset:2048 sc1
    s_waitcnt vmcnt(12)
    v_mfma_f32_32x32x16_bf16 v[16:31], v[184:187], a[184:187], v[16:31]
    v_mfma_f32_32x32x16_bf16 v[48:63], v[184:187], a[188:191], v[48:63]
    s_add_u32 s63, s64, 45056
    buffer_load_dwordx4 v[176:179], v204, s[16:19], s63 offen offset:0 sc1
    v_mfma_f32_32x32x16_bf16 v[32:47], v[188:191], a[184:187], v[32:47]
    v_mfma_f32_32x32x16_bf16 v[64:79], v[188:191], a[188:191], v[64:79]
    buffer_load_dwordx4 v[180:183], v205, s[16:19], s63 offen offset:0 sc1
    s_waitcnt vmcnt(12)
    v_mfma_f32_32x32x16_bf16 v[16:31], v[128:131], a[0:3], v[16:31]
    v_mfma_f32_32x32x16_bf16 v[48:63], v[128:131], a[4:7], v[48:63]
    buffer_load_dwordx4 v[184:187], v204, s[16:19], s63 offen offset:2048 sc1
    v_mfma_f32_32x32x16_bf16 v[32:47], v[132:135], a[0:3], v[32:47]
    v_mfma_f32_32x32x16_bf16 v[64:79], v[132:135], a[4:7], v[64:79]
    buffer_load_dwordx4 v[188:191], v205, s[16:19], s63 offen offset:2048 sc1
    s_waitcnt vmcnt(12)
    v_mfma_f32_32x32x16_bf16 v[16:31], v[136:139], a[8:11], v[16:31]
    v_mfma_f32_32x32x16_bf16 v[48:63], v[136:139], a[12:15], v[48:63]
    s_add_u32 s63, s64, 49152
    buffer_load_dwordx4 v[128:131], v204, s[16:19], s63 offen offset:0 sc1
    v_mfma_f32_32x32x16_bf16 v[32:47], v[140:143], a[8:11], v[32:47]
    v_mfma_f32_32x32x16_bf16 v[64:79], v[140:143], a[12:15], v[64:79]
    buffer_load_dwordx4 v[132:135], v205, s[16:19], s63 offen offset:0 sc1
    s_waitcnt vmcnt(12)
    v_mfma_f32_32x32x16_bf16 v[16:31], v[144:147], a[16:19], v[16:31]
    v_mfma_f32_32x32x16_bf16 v[48:63], v[144:147], a[20:23], v[48:63]
    buffer_load_dwordx4 v[136:139], v204, s[16:19], s63 offen offset:2048 sc1
    v_mfma_f32_32x32x16_bf16 v[32:47], v[148:151], a[16:19], v[32:47]
    v_mfma_f32_32x32x16_bf16 v[64:79], v[148:151], a[20:23], v[64:79]
    buffer_load_dwordx4 v[140:143], v205, s[16:19], s63 offen offset:2048 sc1
    s_waitcnt vmcnt(12)
    v_mfma_f32_32x32x16_bf16 v[16:31], v[152:155], a[24:27], v[16:31]
    v_mfma_f32_32x32x16_bf16 v[48:63], v[152:155], a[28:31], v[48:63]
    s_add_u32 s63, s64, 53248
    buffer_load_dwordx4 v[144:147], v204, s[16:19], s63 offen offset:0 sc1
    v_mfma_f32_32x32x16_bf16 v[32:47], v[156:159], a[24:27], v[32:47]
    v_mfma_f32_32x32x16_bf16 v[64:79], v[156:159], a[28:31], v[64:79]
    buffer_load_dwordx4 v[148:151], v205, s[16:19], s63 offen offset:0 sc1
    s_waitcnt vmcnt(12)
    v_mfma_f32_32x32x16_bf16 v[16:31], v[160:163], a[32:35], v[16:31]
    v_mfma_f32_32x32x16_bf16 v[48:63], v[160:163], a[36:39], v[48:63]
    buffer_load_dwordx4 v[152:155], v204, s[16:19], s63 offen offset:2048 sc1
    v_mfma_f32_32x32x16_bf16 v[32:47], v[164:167], a[32:35], v[32:47]
    v_mfma_f32_32x32x16_bf16 v[64:79], v[164:167], a[36:39], v[64:79]
    buffer_load_dwordx4 v[156:159], v205, s[16:19], s63 offen offset:2048 sc1
    s_waitcnt vmcnt(12) lgkmcnt(0)
    v_mfma_f32_32x32x16_bf16 v[16:31], v[168:171], a[40:43], v[16:31]
    v_mfma_f32_32x32x16_bf16 v[48:63], v[168:171], a[44:47], v[48:63]
    v_mfma_f32_32x32x16_bf16 v[32:47], v[172:175], a[40:43], v[32:47]
    v_mfma_f32_32x32x16_bf16 v[64:79], v[172:175], a[44:47], v[64:79]
    s_waitcnt vmcnt(10)
    v_mfma_f32_32x32x16_bf16 v[16:31], v[176:179], a[48:51], v[16:31]
    v_mfma_f32_32x32x16_bf16 v[48:63], v[176:179], a[52:55], v[48:63]
    v_mfma_f32_32x32x16_bf16 v[32:47], v[180:183], a[48:51], v[32:47]
    v_mfma_f32_32x32x16_bf16 v[64:79], v[180:183], a[52:55], v[64:79]
    s_waitcnt vmcnt(8)
    v_mfma_f32_32x32x16_bf16 v[16:31], v[184:187], a[56:59], v[16:31]
    v_mfma_f32_32x32x16_bf16 v[48:63], v[184:187], a[60:63], v[48:63]
    v_mfma_f32_32x32x16_bf16 v[32:47], v[188:191], a[56:59], v[32:47]
    v_mfma_f32_32x32x16_bf16 v[64:79], v[188:191], a[60:63], v[64:79]
    s_waitcnt vmcnt(6)
    v_mfma_f32_32x32x16_bf16 v[16:31], v[128:131], a[192:195], v[16:31]
    v_lshlrev_b32 v104, 16, v240
    v_and_b32 v105, 0xffff0000, v240
    v_mfma_f32_32x32x16_bf16 v[48:63], v[128:131], a[196:199], v[48:63]
    v_lshlrev_b32 v106, 16, v241
    v_and_b32 v107, 0xffff0000, v241
    v_mfma_f32_32x32x16_bf16 v[32:47], v[132:135], a[192:195], v[32:47]
    v_lshlrev_b32 v108, 16, v242
    v_and_b32 v109, 0xffff0000, v242
    v_mfma_f32_32x32x16_bf16 v[64:79], v[132:135], a[196:199], v[64:79]
    v_lshlrev_b32 v110, 16, v243
    v_and_b32 v111, 0xffff0000, v243
    s_waitcnt vmcnt(4)
    v_mfma_f32_32x32x16_bf16 v[16:31], v[136:139], a[200:203], v[16:31]
    v_lshlrev_b32 v112, 16, v244
    v_and_b32 v113, 0xffff0000, v244
    v_mfma_f32_32x32x16_bf16 v[48:63], v[136:139], a[204:207], v[48:63]
    v_lshlrev_b32 v114, 16, v245
    v_and_b32 v115, 0xffff0000, v245
    v_mfma_f32_32x32x16_bf16 v[32:47], v[140:143], a[200:203], v[32:47]
    v_lshlrev_b32 v116, 16, v246
    v_and_b32 v117, 0xffff0000, v246
    v_mfma_f32_32x32x16_bf16 v[64:79], v[140:143], a[204:207], v[64:79]
    v_lshlrev_b32 v118, 16, v247
    v_and_b32 v119, 0xffff0000, v247
    s_waitcnt vmcnt(2)
    v_mfma_f32_32x32x16_bf16 v[16:31], v[144:147], a[208:211], v[16:31]
    v_lshlrev_b32 v8, 16, v120
    v_mfma_f32_32x32x16_bf16 v[48:63], v[144:147], a[212:215], v[48:63]
    v_add_f32 v104, v104, v8
    v_add_f32 v105, v105, v8
    v_add_f32 v106, v106, v8
    v_add_f32 v107, v107, v8
    v_mfma_f32_32x32x16_bf16 v[32:47], v[148:151], a[208:211], v[32:47]
    v_add_f32 v108, v108, v8
    v_add_f32 v109, v109, v8
    v_add_f32 v110, v110, v8
    v_add_f32 v111, v111, v8
    v_mfma_f32_32x32x16_bf16 v[64:79], v[148:151], a[212:215], v[64:79]
    s_waitcnt vmcnt(0)
    v_mfma_f32_32x32x16_bf16 v[16:31], v[152:155], a[216:219], v[16:31]
    v_add_f32 v112, v112, v8
    v_add_f32 v113, v113, v8
    v_add_f32 v114, v114, v8
    v_add_f32 v115, v115, v8
    v_mfma_f32_32x32x16_bf16 v[48:63], v[152:155], a[220:223], v[48:63]
    v_add_f32 v116, v116, v8
    v_add_f32 v117, v117, v8
    v_add_f32 v118, v118, v8
    v_add_f32 v119, v119, v8
    v_mfma_f32_32x32x16_bf16 v[32:47], v[156:159], a[216:219], v[32:47]
    v_mfma_f32_32x32x16_bf16 v[64:79], v[156:159], a[220:223], v[64:79]
    s_nop 10
    ds_write_b128 v210, v[32:35] offset:0
    ds_write_b128 v210, v[36:39] offset:1024
    ds_write_b128 v210, v[40:43] offset:2048
    ds_write_b128 v210, v[44:47] offset:3072
    ds_write_b128 v209, v[48:51] offset:0
    ds_write_b128 v209, v[52:55] offset:1024
    ds_write_b128 v209, v[56:59] offset:2048
    ds_write_b128 v209, v[60:63] offset:3072
    ds_write_b128 v211, v[64:67] offset:0
    ds_write_b128 v211, v[68:71] offset:1024
    ds_write_b128 v211, v[72:75] offset:2048
    ds_write_b128 v211, v[76:79] offset:3072
    s_waitcnt lgkmcnt(0)
    s_barrier
    ds_read_b128 v[32:35], v212 offset:0
    ds_read_b128 v[36:39], v212 offset:1024
    ds_read_b128 v[40:43], v212 offset:2048
    ds_read_b128 v[44:47], v212 offset:3072
    ds_read_b128 v[48:51], v212 offset:4096
    ds_read_b128 v[52:55], v212 offset:5120
    ds_read_b128 v[56:59], v212 offset:6144
    ds_read_b128 v[60:63], v212 offset:7168
    ds_read_b128 v[64:67], v212 offset:8192
    ds_read_b128 v[68:71], v212 offset:9216
    ds_read_b128 v[72:75], v212 offset:10240
    ds_read_b128 v[76:79], v212 offset:11264
    v_pk_add_f32 v[16:17], v[16:17], v[104:105]
    v_pk_add_f32 v[18:19], v[18:19], v[106:107]
    v_pk_add_f32 v[20:21], v[20:21], v[108:109]
    v_pk_add_f32 v[22:23], v[22:23], v[110:111]
    v_pk_add_f32 v[24:25], v[24:25], v[112:113]
    v_pk_add_f32 v[26:27], v[26:27], v[114:115]
    v_pk_add_f32 v[28:29], v[28:29], v[116:117]
    v_pk_add_f32 v[30:31], v[30:31], v[118:119]
    s_waitcnt lgkmcnt(8)
    s_nop 0
    v_pk_add_f32 v[16:17], v[16:17], v[32:33]
    v_pk_add_f32 v[18:19], v[18:19], v[34:35]
    v_pk_add_f32 v[20:21], v[20:21], v[36:37]
    v_pk_add_f32 v[22:23], v[22:23], v[38:39]
    v_pk_add_f32 v[24:25], v[24:25], v[40:41]
    v_pk_add_f32 v[26:27], v[26:27], v[42:43]
    v_pk_add_f32 v[28:29], v[28:29], v[44:45]
    v_pk_add_f32 v[30:31], v[30:31], v[46:47]
    s_waitcnt lgkmcnt(4)
    s_nop 0
    v_pk_add_f32 v[16:17], v[16:17], v[48:49]
    v_pk_add_f32 v[18:19], v[18:19], v[50:51]
    v_pk_add_f32 v[20:21], v[20:21], v[52:53]
    v_pk_add_f32 v[22:23], v[22:23], v[54:55]
    v_pk_add_f32 v[24:25], v[24:25], v[56:57]
    v_pk_add_f32 v[26:27], v[26:27], v[58:59]
    v_pk_add_f32 v[28:29], v[28:29], v[60:61]
    v_pk_add_f32 v[30:31], v[30:31], v[62:63]
    s_waitcnt lgkmcnt(0)
    s_nop 0
    v_pk_add_f32 v[16:17], v[16:17], v[64:65]
    v_pk_add_f32 v[18:19], v[18:19], v[66:67]
    v_pk_add_f32 v[20:21], v[20:21], v[68:69]
    v_pk_add_f32 v[22:23], v[22:23], v[70:71]
    v_pk_add_f32 v[24:25], v[24:25], v[72:73]
    v_pk_add_f32 v[26:27], v[26:27], v[74:75]
    v_pk_add_f32 v[28:29], v[28:29], v[76:77]
    v_pk_add_f32 v[30:31], v[30:31], v[78:79]
    v_cvt_pk_bf16_f32 v32, v16, v17
    v_cvt_pk_bf16_f32 v33, v18, v19
    v_cvt_pk_bf16_f32 v34, v20, v21
    v_cvt_pk_bf16_f32 v35, v22, v23
    s_nop 0
    v_permlane32_swap_b32 v32, v34
    v_permlane32_swap_b32 v33, v35
    buffer_store_dwordx4 v[32:35], v215, s[32:35], s6 offen offset:0
    v_cvt_pk_bf16_f32 v36, v24, v25
    v_cvt_pk_bf16_f32 v37, v26, v27
    v_cvt_pk_bf16_f32 v38, v28, v29
    v_cvt_pk_bf16_f32 v39, v30, v31
    s_nop 0
    v_permlane32_swap_b32 v36, v38
    v_permlane32_swap_b32 v37, v39
    buffer_store_dwordx4 v[36:39], v215, s[32:35], s6 offen offset:32
L_fin:
L_end:
    s_endpgm
.section .rodata,"a"
.p2align 6
.amdhsa_kernel sequential_preLN__linear_kernel_hedgehog__mixer_token_mlp__prompt_kernel
  .amdhsa_next_free_vgpr 512
  .amdhsa_next_free_sgpr 102
  .amdhsa_accum_offset 256
  .amdhsa_group_segment_fixed_size 0
  .amdhsa_kernarg_size 96
  .amdhsa_user_sgpr_count 2
  .amdhsa_user_sgpr_kernarg_segment_ptr 1
  .amdhsa_system_sgpr_workgroup_id_x 1
  .amdhsa_float_denorm_mode_32 3
.end_amdhsa_kernel
```
